```python
import torch

def _softmax(x, axis=-1):
    return torch.softmax(x, dim=axis)
def _gelu(x):
    return torch.nn.functional.gelu(x, approximate="tanh")
def _silu(x):
    return torch.nn.functional.silu(x)
def _sigmoid(x):
    return torch.sigmoid(x)
def _layernorm(x, axis=-1, eps=1e-5):
    m = x.mean(dim=axis, keepdim=True)
    v = x.var(dim=axis, keepdim=True, unbiased=False)
    return (x - m) / torch.sqrt(v + eps)
def _scatter_add(tgt, idx, src, axis=0):
    return tgt.clone().index_add_(axis, idx, src)
def _segment_sum(src, seg, n):
    out = torch.zeros((n,) + src.shape[1:], dtype=src.dtype)
    return out.index_add_(0, seg, src)
def _pad(x, pw):
    flat = tuple(v for pair in reversed(pw) for v in pair)
    return torch.nn.functional.pad(x, flat)

kernel_name = 'recurrent_scan__gqa_block_cached__swiglu_ffn__decode'

def setup_inputs():

    _w = (lambda a: (lambda t: t.to(torch.bfloat16) if t.is_floating_point() else t)(torch.as_tensor(a)))
    def _A_setup():
        B, Sq, D = 1, 1, 512
        Hq, Hkv, Sk, Dh = 32, 8, 32768, 128
        assert Hq % Hkv == 0, (Hq, Hkv)
        return {
            "x": _w((lambda *s: torch.randn(*s, dtype=torch.bfloat16) * 0.05)(B, Sq, D)),
            "k_cache": _w((lambda *s: torch.randn(*s, dtype=torch.bfloat16) * 0.8)(B, Hkv, Sk, Dh)),
            "v_cache": _w((lambda *s: torch.randn(*s, dtype=torch.bfloat16) * 0.8)(B, Hkv, Sk, Dh)),
            "wq": _w((lambda *s: torch.randn(*s, dtype=torch.bfloat16) * 0.8)(D, Hq * Dh) * (D ** -0.5)),
            "wo": _w((lambda *s: torch.randn(*s, dtype=torch.bfloat16) * 0.8)(Hq * Dh, D) * ((Hq * Dh) ** -0.5)),
        }
    _A_in = _A_setup()

    def _B_setup():
        B, S, D, F = 1, 1, 512, 1792
        return {
            "x": _w((lambda *s: torch.randn(*s, dtype=torch.bfloat16) * 0.05)(B, S, D)),
            "w_gate": _w((lambda *s: torch.randn(*s, dtype=torch.bfloat16) * 0.2)(D, F)),
            "w_up": _w((lambda *s: torch.randn(*s, dtype=torch.bfloat16) * 0.2)(D, F)),
            "w_down": _w((lambda *s: torch.randn(*s, dtype=torch.bfloat16) * 0.2)(F, D)),
        }
    _B_in = _B_setup()

    return {
        "A_x": _A_in["x"],
        "A_k_cache": _A_in["k_cache"],
        "A_v_cache": _A_in["v_cache"],
        "A_wq": _A_in["wq"],
        "A_wo": _A_in["wo"],
        "B_x": _B_in["x"],
        "B_w_gate": _B_in["w_gate"],
        "B_w_up": _B_in["w_up"],
        "B_w_down": _B_in["w_down"],
    }

def reference(A_x, A_k_cache, A_v_cache, A_wq, A_wo, B_x, B_w_gate, B_w_up, B_w_down):
    def _A_ref(x, k_cache, v_cache, wq, wo):
        B, Sq, D = x.shape
        Hq, Dh = 32, 128
        Hkv = k_cache.shape[1]
        rep = Hq // Hkv
        q = (lambda x, *d: x.permute(*d))((x @ wq).reshape(B, Sq, Hq, Dh), 0, 2, 1, 3)
        k = (lambda x, n, axis: torch.repeat_interleave(x, n, dim=axis))(k_cache, rep, axis=1)
        v = (lambda x, n, axis: torch.repeat_interleave(x, n, dim=axis))(v_cache, rep, axis=1)
        scores = torch.einsum("bhqd,bhkd->bhqk", q, k) * (Dh ** -0.5)
        p = _softmax(scores, axis=-1)
        o = torch.einsum("bhqk,bhkd->bhqd", p, v)
        return (lambda x, *d: x.permute(*d))(o, 0, 2, 1, 3).reshape(B, Sq, Hq * Dh) @ wo

    def _B_ref(x, w_gate, w_up, w_down):
        g = _silu(x @ w_gate)
        u = x @ w_up
        return (g * u) @ w_down

    x = A_x
    xn = _layernorm(x, axis=-1)
    s = _A_ref(xn, A_k_cache, A_v_cache, A_wq, A_wo)
    g = _silu(_B_ref(xn, B_w_gate, B_w_up, B_w_down))
    return x + s * g
```

```asm
; @launch grid=(256,1,1) block=(512,1,1) lds=38144
.amdgcn_target "amdgcn-amd-amdhsa--gfx950"
.text
.globl recurrent_scan__gqa_block_cached__swiglu_ffn__decode_kernel
.p2align 8
.type recurrent_scan__gqa_block_cached__swiglu_ffn__decode_kernel,@function
recurrent_scan__gqa_block_cached__swiglu_ffn__decode_kernel:
    s_load_dwordx16 s[4:19], s[0:1], 0
    s_load_dwordx8 s[20:27], s[0:1], 64
    s_cmp_ge_u32 s2, 0x100
    s_cbranch_scc1 L_end
    v_lshrrev_b32 v4, 6, v0
    v_and_b32 v1, 63, v0
    v_readfirstlane_b32 s54, v4
    s_and_b32 s52, s2, 7
    s_lshr_b32 s53, s2, 3
    s_cmp_ge_u32 s54, 4
    s_cbranch_scc1 L_helper
    s_lshl_b32 s57, s52, 23
    s_lshl_b32 s58, s53, 18
    s_add_u32 s57, s57, s58
    s_lshl_b32 s58, s54, 10
    s_add_u32 s57, s57, s58
    v_bfe_u32 v60, v1, 2, 2
    v_lshlrev_b32 v60, 8, v60
    v_and_b32 v61, 3, v1
    v_lshl_add_u32 v60, v61, 4, v60
    v_lshrrev_b32 v62, 4, v1
    v_lshlrev_b32 v62, 6, v62
    v_add3_u32 v2, v60, v62, s57
    v_lshl_add_u32 v3, v1, 4, s57
    s_waitcnt lgkmcnt(0)
    s_mov_b64 s[28:29], s[6:7]
    s_mov_b32 s30, 0x4000000
    s_mov_b32 s31, 0x20000
    buffer_load_dwordx4 v[80:83], v2, s[28:31], 0 offen sc1 nt
    s_mov_b64 s[36:37], s[10:11]
    s_mov_b32 s38, 0x400000
    s_mov_b32 s39, 0x20000
    s_and_b32 s57, s53, 3
    s_lshl_b32 s57, s57, 7
    s_lshl_b32 s58, s54, 2
    s_add_u32 s57, s57, s58
    v_lshrrev_b32 v60, 3, v1
    v_lshl_add_u32 v60, v60, 4, s57
    v_and_b32 v61, 7, v1
    v_lshlrev_b32 v61, 4, v61
    s_lshr_b32 s59, s53, 2
    s_lshl_b32 s57, s52, 10
    s_lshl_b32 s58, s59, 7
    s_add_u32 s57, s57, s58
    v_lshlrev_b32 v76, 13, v60
    v_add3_u32 v76, v76, v61, s57
    s_lshl_b32 s58, s54, 12
    s_add_u32 m0, s58, 5376
    s_nop 0
    buffer_load_dwordx4 v76, s[36:39], 0 offen offset:0 sc1 nt lds
    s_mov_b32 s56, 0x1c00
    buffer_load_dwordx4 v76, s[36:39], s56 offen offset:1024 sc1 nt lds
    s_mov_b32 s56, 0x3800
    buffer_load_dwordx4 v76, s[36:39], s56 offen offset:2048 sc1 nt lds
    s_mov_b32 s56, 0x5400
    buffer_load_dwordx4 v76, s[36:39], s56 offen offset:3072 sc1 nt lds
    s_load_dword s55, s[26:27], 0xe0000
    s_mov_b64 s[48:49], s[26:27]
    s_mov_b32 s50, 0x10000000
    s_mov_b32 s51, 0x20000
    s_mov_b64 s[32:33], s[8:9]
    s_mov_b32 s34, 0x4000000
    s_mov_b32 s35, 0x20000
    s_mov_b32 s60, 0x05040100
    s_mov_b32 s61, 0x07060302
    s_mov_b32 s62, 0x3fb8aa3b
    s_lshl_b32 s59, s59, 3
    s_add_u32 s59, s59, s52
    s_sub_u32 s57, s59, 28
    s_cmp_ge_u32 s59, 28
    s_cselect_b32 s59, s57, s59
    s_cselect_b64 s[40:41], s[18:19], s[16:17]
    s_mov_b32 s42, 0x1c0000
    s_mov_b32 s43, 0x20000
    s_lshl_b32 s59, s59, 7
    s_cmp_ge_u32 s53, 28
    s_cselect_b32 s59, 0x10000000, s59
    s_add_u32 m0, s58, 21760
    v_mul_u32_u24 v77, 3584, v60
    v_add3_u32 v77, v77, v61, s59
    buffer_load_dwordx4 v77, s[40:43], 0 offen offset:0 sc1 nt lds
    s_mov_b32 s56, 0xa00
    buffer_load_dwordx4 v77, s[40:43], s56 offen offset:1024 sc1 nt lds
    s_waitcnt vmcnt(6)
    s_mov_b32 s56, 0x1400
    buffer_load_dwordx4 v77, s[40:43], s56 offen offset:2048 sc1 nt lds
    s_waitcnt vmcnt(6)
    s_mov_b32 s56, 0x1e00
    buffer_load_dwordx4 v77, s[40:43], s56 offen offset:3072 sc1 nt lds
    s_waitcnt vmcnt(6)
    s_mov_b32 s56, 0x1000
    buffer_load_dwordx4 v[84:87], v2, s[28:31], s56 offen sc1 nt
    s_waitcnt vmcnt(6)
    s_mov_b32 s56, 0x2000
    buffer_load_dwordx4 v[88:91], v2, s[28:31], s56 offen sc1 nt
    s_waitcnt vmcnt(6)
    s_mov_b32 s56, 0x3000
    buffer_load_dwordx4 v[92:95], v2, s[28:31], s56 offen sc1 nt
    s_waitcnt vmcnt(6)
    s_mov_b32 s56, 0x4000
    buffer_load_dwordx4 v[96:99], v2, s[28:31], s56 offen sc1 nt
    s_waitcnt vmcnt(6)
    s_mov_b32 s56, 0x5000
    buffer_load_dwordx4 v[100:103], v2, s[28:31], s56 offen sc1 nt
    s_waitcnt vmcnt(6)
    s_mov_b32 s56, 0x6000
    buffer_load_dwordx4 v[104:107], v2, s[28:31], s56 offen sc1 nt
    s_waitcnt vmcnt(6)
    s_mov_b32 s56, 0x7000
    buffer_load_dwordx4 v[108:111], v2, s[28:31], s56 offen sc1 nt
    s_waitcnt vmcnt(4)
    s_mov_b32 s56, 0x8000
    buffer_load_dwordx4 v[112:115], v2, s[28:31], s56 offen sc1 nt
    s_waitcnt vmcnt(4)
    s_mov_b32 s56, 0x9000
    buffer_load_dwordx4 v[116:119], v2, s[28:31], s56 offen sc1 nt
    s_waitcnt vmcnt(4)
    s_mov_b32 s56, 0xa000
    buffer_load_dwordx4 v[120:123], v2, s[28:31], s56 offen sc1 nt
    s_waitcnt vmcnt(4)
    s_mov_b32 s56, 0xb000
    buffer_load_dwordx4 v[124:127], v2, s[28:31], s56 offen sc1 nt
    s_barrier
    s_waitcnt vmcnt(4)
    s_mov_b32 s56, 0xc000
    buffer_load_dwordx4 v[128:131], v2, s[28:31], s56 offen sc1 nt
    s_waitcnt vmcnt(4)
    s_mov_b32 s56, 0xd000
    buffer_load_dwordx4 v[132:135], v2, s[28:31], s56 offen sc1 nt
    s_waitcnt vmcnt(4)
    s_mov_b32 s56, 0xe000
    buffer_load_dwordx4 v[136:139], v2, s[28:31], s56 offen sc1 nt
    s_waitcnt vmcnt(4)
    s_mov_b32 s56, 0xf000
    buffer_load_dwordx4 v[140:143], v2, s[28:31], s56 offen sc1 nt
    s_waitcnt vmcnt(4)
    s_mov_b32 s56, 0x10000
    buffer_load_dwordx4 v[144:147], v2, s[28:31], s56 offen sc1 nt
    s_waitcnt vmcnt(4)
    s_mov_b32 s56, 0x11000
    buffer_load_dwordx4 v[148:151], v2, s[28:31], s56 offen sc1 nt
    s_waitcnt vmcnt(4)
    s_mov_b32 s56, 0x12000
    buffer_load_dwordx4 v[152:155], v2, s[28:31], s56 offen sc1 nt
    s_waitcnt vmcnt(4)
    s_mov_b32 s56, 0x13000
    buffer_load_dwordx4 v[156:159], v2, s[28:31], s56 offen sc1 nt
    s_waitcnt vmcnt(4)
    s_mov_b32 s56, 0x14000
    buffer_load_dwordx4 v[160:163], v2, s[28:31], s56 offen sc1 nt
    s_waitcnt vmcnt(4)
    s_mov_b32 s56, 0x15000
    buffer_load_dwordx4 v[164:167], v2, s[28:31], s56 offen sc1 nt
    s_waitcnt vmcnt(4)
    s_mov_b32 s56, 0x16000
    buffer_load_dwordx4 v[168:171], v2, s[28:31], s56 offen sc1 nt
    s_waitcnt vmcnt(4)
    s_mov_b32 s56, 0x17000
    buffer_load_dwordx4 v[172:175], v2, s[28:31], s56 offen sc1 nt
    s_barrier
    v_mov_b32 v79, 5240
    s_waitcnt vmcnt(4)
    s_mov_b32 s56, 0x18000
    buffer_load_dwordx4 v[176:179], v2, s[28:31], s56 offen sc1 nt
    s_waitcnt vmcnt(4)
    s_mov_b32 s56, 0x19000
    buffer_load_dwordx4 v[180:183], v2, s[28:31], s56 offen sc1 nt
    s_waitcnt vmcnt(4)
    s_mov_b32 s56, 0x1a000
    buffer_load_dwordx4 v[184:187], v2, s[28:31], s56 offen sc1 nt
    s_waitcnt vmcnt(4)
    s_mov_b32 s56, 0x1b000
    buffer_load_dwordx4 v[188:191], v2, s[28:31], s56 offen sc1 nt
    s_waitcnt vmcnt(4)
    s_mov_b32 s56, 0x1c000
    buffer_load_dwordx4 v[192:195], v2, s[28:31], s56 offen sc1 nt
    s_waitcnt vmcnt(4)
    s_mov_b32 s56, 0x1d000
    buffer_load_dwordx4 v[196:199], v2, s[28:31], s56 offen sc1 nt
    s_waitcnt vmcnt(4)
    ds_read_b32 v78, v79
    s_mov_b32 s56, 0x1e000
    buffer_load_dwordx4 v[200:203], v2, s[28:31], s56 offen sc1 nt
    s_waitcnt vmcnt(4)
    s_waitcnt lgkmcnt(0)
    v_cmp_ne_u32 vcc, 0, v78
    s_mov_b32 s56, 0x1f000
    buffer_load_dwordx4 v[204:207], v2, s[28:31], s56 offen sc1 nt
    s_cbranch_vccnz L_deep_1
    s_waitcnt vmcnt(4)
L_deep_1:
    s_mov_b32 s56, 0x20000
    buffer_load_dwordx4 v[208:211], v2, s[28:31], s56 offen sc1 nt
    s_waitcnt vmcnt(5)
    s_cbranch_vccnz L_deep_2
    s_waitcnt vmcnt(4)
L_deep_2:
    s_mov_b32 s56, 0x21000
    buffer_load_dwordx4 v[212:215], v2, s[28:31], s56 offen sc1 nt
    s_waitcnt vmcnt(5)
    s_cbranch_vccnz L_deep_3
    s_waitcnt vmcnt(4)
L_deep_3:
    s_mov_b32 s56, 0x22000
    buffer_load_dwordx4 v[216:219], v2, s[28:31], s56 offen sc1 nt
    s_waitcnt vmcnt(5)
    s_cbranch_vccnz L_deep_4
    s_waitcnt vmcnt(4)
L_deep_4:
    s_mov_b32 s56, 0x23000
    buffer_load_dwordx4 v[220:223], v2, s[28:31], s56 offen sc1 nt
    s_waitcnt vmcnt(5)
    s_cbranch_vccnz L_deep_5
    s_waitcnt vmcnt(4)
L_deep_5:
    s_mov_b32 s56, 0x24000
    buffer_load_dwordx4 v[224:227], v2, s[28:31], s56 offen sc1 nt
    s_waitcnt vmcnt(5)
    s_cbranch_vccnz L_deep_6
    s_waitcnt vmcnt(4)
L_deep_6:
    s_mov_b32 s56, 0x25000
    buffer_load_dwordx4 v[228:231], v2, s[28:31], s56 offen sc1 nt
    s_waitcnt vmcnt(5)
    s_cbranch_vccnz L_deep_7
    s_waitcnt vmcnt(4)
L_deep_7:
    s_mov_b32 s56, 0x26000
    buffer_load_dwordx4 v[232:235], v2, s[28:31], s56 offen sc1 nt
    s_waitcnt vmcnt(5)
    s_cbranch_vccnz L_deep_8
    s_waitcnt vmcnt(4)
L_deep_8:
    s_mov_b32 s56, 0x27000
    buffer_load_dwordx4 v[236:239], v2, s[28:31], s56 offen sc1 nt
    s_waitcnt vmcnt(5)
    s_cbranch_vccnz L_deep_9
    s_waitcnt vmcnt(4)
L_deep_9:
    s_mov_b32 s56, 0x28000
    buffer_load_dwordx4 v[240:243], v2, s[28:31], s56 offen sc1 nt
    s_waitcnt vmcnt(5)
    s_cbranch_vccnz L_deep_10
    s_waitcnt vmcnt(4)
L_deep_10:
    s_mov_b32 s56, 0x29000
    buffer_load_dwordx4 v[244:247], v2, s[28:31], s56 offen sc1 nt
    s_waitcnt vmcnt(5)
    s_cbranch_vccnz L_deep_11
    s_waitcnt vmcnt(4)
L_deep_11:
    s_mov_b32 s56, 0x2a000
    buffer_load_dwordx4 v[248:251], v2, s[28:31], s56 offen sc1 nt
    s_waitcnt vmcnt(5)
    s_cbranch_vccnz L_deep_12
    s_waitcnt vmcnt(4)
L_deep_12:
    s_mov_b32 s56, 0x2b000
    buffer_load_dwordx4 v[252:255], v2, s[28:31], s56 offen sc1 nt
    v_lshlrev_b32 v60, 4, v1
    s_waitcnt lgkmcnt(0)
    s_barrier
    ds_read_b128 v[52:55], v60 offset:0
    s_and_b32 s57, s55, 0x7f7f7f7f
    s_add_u32 s57, s57, 0x47611b35
    s_and_b32 s55, s55, 0x80808080
    s_xor_b32 s55, s55, s57
    v_and_b32 v66, 3, v1
    v_lshlrev_b32 v66, 4, v66
    s_lshl_b32 s57, s54, 2
    v_add_u32 v67, s57, v66
    s_waitcnt lgkmcnt(0)
    v_mfma_f32_16x16x32_bf16 v[36:39], v[80:83], v[52:55], 0
    v_mfma_f32_16x16x32_bf16 v[40:43], v[84:87], v[52:55], 0
    v_mfma_f32_16x16x32_bf16 v[44:47], v[88:91], v[52:55], 0
    v_mfma_f32_16x16x32_bf16 v[48:51], v[92:95], v[52:55], 0
    s_nop 5
    v_add_f32_dpp v4, v37, v36 row_ror:12 row_mask:0xf bank_mask:0x1
    v_add_f32_dpp v5, v41, v40 row_ror:12 row_mask:0xf bank_mask:0x1
    v_add_f32_dpp v6, v45, v44 row_ror:12 row_mask:0xf bank_mask:0x1
    v_add_f32_dpp v7, v49, v48 row_ror:12 row_mask:0xf bank_mask:0x1
    v_add_f32_dpp v4, v38, v4 row_ror:8 row_mask:0xf bank_mask:0x1
    v_add_f32_dpp v5, v42, v5 row_ror:8 row_mask:0xf bank_mask:0x1
    v_add_f32_dpp v6, v46, v6 row_ror:8 row_mask:0xf bank_mask:0x1
    v_add_f32_dpp v7, v50, v7 row_ror:8 row_mask:0xf bank_mask:0x1
    v_add_f32_dpp v4, v39, v4 row_ror:4 row_mask:0xf bank_mask:0x1
    v_add_f32_dpp v5, v43, v5 row_ror:4 row_mask:0xf bank_mask:0x1
    v_add_f32_dpp v6, v47, v6 row_ror:4 row_mask:0xf bank_mask:0x1
    v_add_f32_dpp v7, v51, v7 row_ror:4 row_mask:0xf bank_mask:0x1
    s_waitcnt vmcnt(5)
    s_cbranch_vccnz L_deep_13
    s_waitcnt vmcnt(4)
L_deep_13:
    s_mov_b32 s56, 0x2c000
    buffer_load_dwordx4 v[80:83], v2, s[28:31], s56 offen sc1 nt
    v_mfma_f32_16x16x32_bf16 v[36:39], v[96:99], v[52:55], 0
    v_mfma_f32_16x16x32_bf16 v[40:43], v[100:103], v[52:55], 0
    v_mfma_f32_16x16x32_bf16 v[44:47], v[104:107], v[52:55], 0
    v_mfma_f32_16x16x32_bf16 v[48:51], v[108:111], v[52:55], 0
    s_nop 5
    v_add_f32_dpp v4, v38, v37 row_ror:12 row_mask:0xf bank_mask:0x2
    v_add_f32_dpp v5, v42, v41 row_ror:12 row_mask:0xf bank_mask:0x2
    v_add_f32_dpp v6, v46, v45 row_ror:12 row_mask:0xf bank_mask:0x2
    v_add_f32_dpp v7, v50, v49 row_ror:12 row_mask:0xf bank_mask:0x2
    v_add_f32_dpp v4, v39, v4 row_ror:8 row_mask:0xf bank_mask:0x2
    v_add_f32_dpp v5, v43, v5 row_ror:8 row_mask:0xf bank_mask:0x2
    v_add_f32_dpp v6, v47, v6 row_ror:8 row_mask:0xf bank_mask:0x2
    v_add_f32_dpp v7, v51, v7 row_ror:8 row_mask:0xf bank_mask:0x2
    v_add_f32_dpp v4, v36, v4 row_ror:4 row_mask:0xf bank_mask:0x2
    v_add_f32_dpp v5, v40, v5 row_ror:4 row_mask:0xf bank_mask:0x2
    v_add_f32_dpp v6, v44, v6 row_ror:4 row_mask:0xf bank_mask:0x2
    v_add_f32_dpp v7, v48, v7 row_ror:4 row_mask:0xf bank_mask:0x2
    s_waitcnt vmcnt(5)
    s_cbranch_vccnz L_deep_14
    s_waitcnt vmcnt(4)
L_deep_14:
    s_mov_b32 s56, 0x2d000
    buffer_load_dwordx4 v[84:87], v2, s[28:31], s56 offen sc1 nt
    v_mfma_f32_16x16x32_bf16 v[36:39], v[112:115], v[52:55], 0
    v_mfma_f32_16x16x32_bf16 v[40:43], v[116:119], v[52:55], 0
    v_mfma_f32_16x16x32_bf16 v[44:47], v[120:123], v[52:55], 0
    v_mfma_f32_16x16x32_bf16 v[48:51], v[124:127], v[52:55], 0
    s_nop 5
    v_add_f32_dpp v4, v39, v38 row_ror:12 row_mask:0xf bank_mask:0x4
    v_add_f32_dpp v5, v43, v42 row_ror:12 row_mask:0xf bank_mask:0x4
    v_add_f32_dpp v6, v47, v46 row_ror:12 row_mask:0xf bank_mask:0x4
    v_add_f32_dpp v7, v51, v50 row_ror:12 row_mask:0xf bank_mask:0x4
    v_add_f32_dpp v4, v36, v4 row_ror:8 row_mask:0xf bank_mask:0x4
    v_add_f32_dpp v5, v40, v5 row_ror:8 row_mask:0xf bank_mask:0x4
    v_add_f32_dpp v6, v44, v6 row_ror:8 row_mask:0xf bank_mask:0x4
    v_add_f32_dpp v7, v48, v7 row_ror:8 row_mask:0xf bank_mask:0x4
    v_add_f32_dpp v4, v37, v4 row_ror:4 row_mask:0xf bank_mask:0x4
    v_add_f32_dpp v5, v41, v5 row_ror:4 row_mask:0xf bank_mask:0x4
    v_add_f32_dpp v6, v45, v6 row_ror:4 row_mask:0xf bank_mask:0x4
    v_add_f32_dpp v7, v49, v7 row_ror:4 row_mask:0xf bank_mask:0x4
    s_waitcnt vmcnt(5)
    s_cbranch_vccnz L_deep_15
    s_waitcnt vmcnt(4)
L_deep_15:
    s_mov_b32 s56, 0x2e000
    buffer_load_dwordx4 v[88:91], v2, s[28:31], s56 offen sc1 nt
    v_mfma_f32_16x16x32_bf16 v[36:39], v[128:131], v[52:55], 0
    v_mfma_f32_16x16x32_bf16 v[40:43], v[132:135], v[52:55], 0
    v_mfma_f32_16x16x32_bf16 v[44:47], v[136:139], v[52:55], 0
    v_mfma_f32_16x16x32_bf16 v[48:51], v[140:143], v[52:55], 0
    s_nop 5
    v_add_f32_dpp v4, v36, v39 row_ror:12 row_mask:0xf bank_mask:0x8
    v_add_f32_dpp v5, v40, v43 row_ror:12 row_mask:0xf bank_mask:0x8
    v_add_f32_dpp v6, v44, v47 row_ror:12 row_mask:0xf bank_mask:0x8
    v_add_f32_dpp v7, v48, v51 row_ror:12 row_mask:0xf bank_mask:0x8
    v_add_f32_dpp v4, v37, v4 row_ror:8 row_mask:0xf bank_mask:0x8
    v_add_f32_dpp v5, v41, v5 row_ror:8 row_mask:0xf bank_mask:0x8
    v_add_f32_dpp v6, v45, v6 row_ror:8 row_mask:0xf bank_mask:0x8
    v_add_f32_dpp v7, v49, v7 row_ror:8 row_mask:0xf bank_mask:0x8
    v_add_f32_dpp v4, v38, v4 row_ror:4 row_mask:0xf bank_mask:0x8
    v_add_f32_dpp v5, v42, v5 row_ror:4 row_mask:0xf bank_mask:0x8
    v_add_f32_dpp v6, v46, v6 row_ror:4 row_mask:0xf bank_mask:0x8
    v_add_f32_dpp v7, v50, v7 row_ror:4 row_mask:0xf bank_mask:0x8
    s_waitcnt vmcnt(5)
    s_cbranch_vccnz L_deep_16
    s_waitcnt vmcnt(4)
L_deep_16:
    s_mov_b32 s56, 0x2f000
    buffer_load_dwordx4 v[92:95], v2, s[28:31], s56 offen sc1 nt
    v_mfma_f32_16x16x32_bf16 v[36:39], v[144:147], v[52:55], 0
    v_mfma_f32_16x16x32_bf16 v[40:43], v[148:151], v[52:55], 0
    v_mfma_f32_16x16x32_bf16 v[44:47], v[152:155], v[52:55], 0
    v_mfma_f32_16x16x32_bf16 v[48:51], v[156:159], v[52:55], 0
    s_nop 5
    v_add_f32_dpp v8, v37, v36 row_ror:12 row_mask:0xf bank_mask:0x1
    v_add_f32_dpp v9, v41, v40 row_ror:12 row_mask:0xf bank_mask:0x1
    v_add_f32_dpp v10, v45, v44 row_ror:12 row_mask:0xf bank_mask:0x1
    v_add_f32_dpp v11, v49, v48 row_ror:12 row_mask:0xf bank_mask:0x1
    v_add_f32_dpp v8, v38, v8 row_ror:8 row_mask:0xf bank_mask:0x1
    v_add_f32_dpp v9, v42, v9 row_ror:8 row_mask:0xf bank_mask:0x1
    v_add_f32_dpp v10, v46, v10 row_ror:8 row_mask:0xf bank_mask:0x1
    v_add_f32_dpp v11, v50, v11 row_ror:8 row_mask:0xf bank_mask:0x1
    v_add_f32_dpp v8, v39, v8 row_ror:4 row_mask:0xf bank_mask:0x1
    v_add_f32_dpp v9, v43, v9 row_ror:4 row_mask:0xf bank_mask:0x1
    v_add_f32_dpp v10, v47, v10 row_ror:4 row_mask:0xf bank_mask:0x1
    v_add_f32_dpp v11, v51, v11 row_ror:4 row_mask:0xf bank_mask:0x1
    s_waitcnt vmcnt(5)
    s_cbranch_vccnz L_deep_17
    s_waitcnt vmcnt(4)
L_deep_17:
    s_mov_b32 s56, 0x30000
    buffer_load_dwordx4 v[96:99], v2, s[28:31], s56 offen sc1 nt
    v_mfma_f32_16x16x32_bf16 v[36:39], v[160:163], v[52:55], 0
    v_mfma_f32_16x16x32_bf16 v[40:43], v[164:167], v[52:55], 0
    v_mfma_f32_16x16x32_bf16 v[44:47], v[168:171], v[52:55], 0
    v_mfma_f32_16x16x32_bf16 v[48:51], v[172:175], v[52:55], 0
    s_nop 5
    v_add_f32_dpp v8, v38, v37 row_ror:12 row_mask:0xf bank_mask:0x2
    v_add_f32_dpp v9, v42, v41 row_ror:12 row_mask:0xf bank_mask:0x2
    v_add_f32_dpp v10, v46, v45 row_ror:12 row_mask:0xf bank_mask:0x2
    v_add_f32_dpp v11, v50, v49 row_ror:12 row_mask:0xf bank_mask:0x2
    v_add_f32_dpp v8, v39, v8 row_ror:8 row_mask:0xf bank_mask:0x2
    v_add_f32_dpp v9, v43, v9 row_ror:8 row_mask:0xf bank_mask:0x2
    v_add_f32_dpp v10, v47, v10 row_ror:8 row_mask:0xf bank_mask:0x2
    v_add_f32_dpp v11, v51, v11 row_ror:8 row_mask:0xf bank_mask:0x2
    v_add_f32_dpp v8, v36, v8 row_ror:4 row_mask:0xf bank_mask:0x2
    v_add_f32_dpp v9, v40, v9 row_ror:4 row_mask:0xf bank_mask:0x2
    v_add_f32_dpp v10, v44, v10 row_ror:4 row_mask:0xf bank_mask:0x2
    v_add_f32_dpp v11, v48, v11 row_ror:4 row_mask:0xf bank_mask:0x2
    s_waitcnt vmcnt(5)
    s_cbranch_vccnz L_deep_18
    s_waitcnt vmcnt(4)
L_deep_18:
    s_mov_b32 s56, 0x31000
    buffer_load_dwordx4 v[100:103], v2, s[28:31], s56 offen sc1 nt
    v_mfma_f32_16x16x32_bf16 v[36:39], v[176:179], v[52:55], 0
    v_mfma_f32_16x16x32_bf16 v[40:43], v[180:183], v[52:55], 0
    v_mfma_f32_16x16x32_bf16 v[44:47], v[184:187], v[52:55], 0
    v_mfma_f32_16x16x32_bf16 v[48:51], v[188:191], v[52:55], 0
    s_nop 5
    v_add_f32_dpp v8, v39, v38 row_ror:12 row_mask:0xf bank_mask:0x4
    v_add_f32_dpp v9, v43, v42 row_ror:12 row_mask:0xf bank_mask:0x4
    v_add_f32_dpp v10, v47, v46 row_ror:12 row_mask:0xf bank_mask:0x4
    v_add_f32_dpp v11, v51, v50 row_ror:12 row_mask:0xf bank_mask:0x4
    v_add_f32_dpp v8, v36, v8 row_ror:8 row_mask:0xf bank_mask:0x4
    v_add_f32_dpp v9, v40, v9 row_ror:8 row_mask:0xf bank_mask:0x4
    v_add_f32_dpp v10, v44, v10 row_ror:8 row_mask:0xf bank_mask:0x4
    v_add_f32_dpp v11, v48, v11 row_ror:8 row_mask:0xf bank_mask:0x4
    v_add_f32_dpp v8, v37, v8 row_ror:4 row_mask:0xf bank_mask:0x4
    v_add_f32_dpp v9, v41, v9 row_ror:4 row_mask:0xf bank_mask:0x4
    v_add_f32_dpp v10, v45, v10 row_ror:4 row_mask:0xf bank_mask:0x4
    v_add_f32_dpp v11, v49, v11 row_ror:4 row_mask:0xf bank_mask:0x4
    s_waitcnt vmcnt(5)
    s_cbranch_vccnz L_deep_19
    s_waitcnt vmcnt(4)
L_deep_19:
    ds_read_b32 v78, v79
    s_mov_b32 s56, 0x32000
    buffer_load_dwordx4 v[104:107], v2, s[28:31], s56 offen sc1 nt
    v_mfma_f32_16x16x32_bf16 v[36:39], v[192:195], v[52:55], 0
    v_mfma_f32_16x16x32_bf16 v[40:43], v[196:199], v[52:55], 0
    v_mfma_f32_16x16x32_bf16 v[44:47], v[200:203], v[52:55], 0
    v_mfma_f32_16x16x32_bf16 v[48:51], v[204:207], v[52:55], 0
    s_nop 5
    v_add_f32_dpp v8, v36, v39 row_ror:12 row_mask:0xf bank_mask:0x8
    v_add_f32_dpp v9, v40, v43 row_ror:12 row_mask:0xf bank_mask:0x8
    v_add_f32_dpp v10, v44, v47 row_ror:12 row_mask:0xf bank_mask:0x8
    v_add_f32_dpp v11, v48, v51 row_ror:12 row_mask:0xf bank_mask:0x8
    v_add_f32_dpp v8, v37, v8 row_ror:8 row_mask:0xf bank_mask:0x8
    v_add_f32_dpp v9, v41, v9 row_ror:8 row_mask:0xf bank_mask:0x8
    v_add_f32_dpp v10, v45, v10 row_ror:8 row_mask:0xf bank_mask:0x8
    v_add_f32_dpp v11, v49, v11 row_ror:8 row_mask:0xf bank_mask:0x8
    v_add_f32_dpp v8, v38, v8 row_ror:4 row_mask:0xf bank_mask:0x8
    v_add_f32_dpp v9, v42, v9 row_ror:4 row_mask:0xf bank_mask:0x8
    v_add_f32_dpp v10, v46, v10 row_ror:4 row_mask:0xf bank_mask:0x8
    v_add_f32_dpp v11, v50, v11 row_ror:4 row_mask:0xf bank_mask:0x8
    s_waitcnt vmcnt(5)
    s_cbranch_vccnz L_deep_20
    s_waitcnt vmcnt(4)
L_deep_20:
    s_waitcnt lgkmcnt(0)
    v_cmp_ne_u32 vcc, 0, v78
    s_mov_b32 s56, 0x33000
    buffer_load_dwordx4 v[108:111], v2, s[28:31], s56 offen sc1 nt
    v_mfma_f32_16x16x32_bf16 v[36:39], v[208:211], v[52:55], 0
    v_mfma_f32_16x16x32_bf16 v[40:43], v[212:215], v[52:55], 0
    v_mfma_f32_16x16x32_bf16 v[44:47], v[216:219], v[52:55], 0
    v_mfma_f32_16x16x32_bf16 v[48:51], v[220:223], v[52:55], 0
    s_nop 5
    v_add_f32_dpp v12, v37, v36 row_ror:12 row_mask:0xf bank_mask:0x1
    v_add_f32_dpp v13, v41, v40 row_ror:12 row_mask:0xf bank_mask:0x1
    v_add_f32_dpp v14, v45, v44 row_ror:12 row_mask:0xf bank_mask:0x1
    v_add_f32_dpp v15, v49, v48 row_ror:12 row_mask:0xf bank_mask:0x1
    v_add_f32_dpp v12, v38, v12 row_ror:8 row_mask:0xf bank_mask:0x1
    v_add_f32_dpp v13, v42, v13 row_ror:8 row_mask:0xf bank_mask:0x1
    v_add_f32_dpp v14, v46, v14 row_ror:8 row_mask:0xf bank_mask:0x1
    v_add_f32_dpp v15, v50, v15 row_ror:8 row_mask:0xf bank_mask:0x1
    v_add_f32_dpp v12, v39, v12 row_ror:4 row_mask:0xf bank_mask:0x1
    v_add_f32_dpp v13, v43, v13 row_ror:4 row_mask:0xf bank_mask:0x1
    v_add_f32_dpp v14, v47, v14 row_ror:4 row_mask:0xf bank_mask:0x1
    v_add_f32_dpp v15, v51, v15 row_ror:4 row_mask:0xf bank_mask:0x1
    s_waitcnt vmcnt(5)
    s_cbranch_vccnz L_deep_21
    s_waitcnt vmcnt(4)
L_deep_21:
    s_mov_b32 s56, 0x34000
    buffer_load_dwordx4 v[112:115], v2, s[28:31], s56 offen sc1 nt
    v_mfma_f32_16x16x32_bf16 v[36:39], v[224:227], v[52:55], 0
    v_mfma_f32_16x16x32_bf16 v[40:43], v[228:231], v[52:55], 0
    v_mfma_f32_16x16x32_bf16 v[44:47], v[232:235], v[52:55], 0
    v_mfma_f32_16x16x32_bf16 v[48:51], v[236:239], v[52:55], 0
    s_nop 5
    v_add_f32_dpp v12, v38, v37 row_ror:12 row_mask:0xf bank_mask:0x2
    v_add_f32_dpp v13, v42, v41 row_ror:12 row_mask:0xf bank_mask:0x2
    v_add_f32_dpp v14, v46, v45 row_ror:12 row_mask:0xf bank_mask:0x2
    v_add_f32_dpp v15, v50, v49 row_ror:12 row_mask:0xf bank_mask:0x2
    v_add_f32_dpp v12, v39, v12 row_ror:8 row_mask:0xf bank_mask:0x2
    v_add_f32_dpp v13, v43, v13 row_ror:8 row_mask:0xf bank_mask:0x2
    v_add_f32_dpp v14, v47, v14 row_ror:8 row_mask:0xf bank_mask:0x2
    v_add_f32_dpp v15, v51, v15 row_ror:8 row_mask:0xf bank_mask:0x2
    v_add_f32_dpp v12, v36, v12 row_ror:4 row_mask:0xf bank_mask:0x2
    v_add_f32_dpp v13, v40, v13 row_ror:4 row_mask:0xf bank_mask:0x2
    v_add_f32_dpp v14, v44, v14 row_ror:4 row_mask:0xf bank_mask:0x2
    v_add_f32_dpp v15, v48, v15 row_ror:4 row_mask:0xf bank_mask:0x2
    s_waitcnt vmcnt(5)
    s_cbranch_vccnz L_deep_22
    s_waitcnt vmcnt(4)
L_deep_22:
    s_mov_b32 s56, 0x35000
    buffer_load_dwordx4 v[116:119], v2, s[28:31], s56 offen sc1 nt
    v_mfma_f32_16x16x32_bf16 v[36:39], v[240:243], v[52:55], 0
    v_mfma_f32_16x16x32_bf16 v[40:43], v[244:247], v[52:55], 0
    v_mfma_f32_16x16x32_bf16 v[44:47], v[248:251], v[52:55], 0
    v_mfma_f32_16x16x32_bf16 v[48:51], v[252:255], v[52:55], 0
    s_nop 5
    v_add_f32_dpp v12, v39, v38 row_ror:12 row_mask:0xf bank_mask:0x4
    v_add_f32_dpp v13, v43, v42 row_ror:12 row_mask:0xf bank_mask:0x4
    v_add_f32_dpp v14, v47, v46 row_ror:12 row_mask:0xf bank_mask:0x4
    v_add_f32_dpp v15, v51, v50 row_ror:12 row_mask:0xf bank_mask:0x4
    v_add_f32_dpp v12, v36, v12 row_ror:8 row_mask:0xf bank_mask:0x4
    v_add_f32_dpp v13, v40, v13 row_ror:8 row_mask:0xf bank_mask:0x4
    v_add_f32_dpp v14, v44, v14 row_ror:8 row_mask:0xf bank_mask:0x4
    v_add_f32_dpp v15, v48, v15 row_ror:8 row_mask:0xf bank_mask:0x4
    v_add_f32_dpp v12, v37, v12 row_ror:4 row_mask:0xf bank_mask:0x4
    v_add_f32_dpp v13, v41, v13 row_ror:4 row_mask:0xf bank_mask:0x4
    v_add_f32_dpp v14, v45, v14 row_ror:4 row_mask:0xf bank_mask:0x4
    v_add_f32_dpp v15, v49, v15 row_ror:4 row_mask:0xf bank_mask:0x4
    s_waitcnt vmcnt(5)
    s_cbranch_vccnz L_deep_23
    s_waitcnt vmcnt(4)
L_deep_23:
    s_mov_b32 s56, 0x36000
    buffer_load_dwordx4 v[120:123], v2, s[28:31], s56 offen sc1 nt
    v_mfma_f32_16x16x32_bf16 v[36:39], v[80:83], v[52:55], 0
    v_mfma_f32_16x16x32_bf16 v[40:43], v[84:87], v[52:55], 0
    v_mfma_f32_16x16x32_bf16 v[44:47], v[88:91], v[52:55], 0
    v_mfma_f32_16x16x32_bf16 v[48:51], v[92:95], v[52:55], 0
    s_nop 5
    v_add_f32_dpp v12, v36, v39 row_ror:12 row_mask:0xf bank_mask:0x8
    v_add_f32_dpp v13, v40, v43 row_ror:12 row_mask:0xf bank_mask:0x8
    v_add_f32_dpp v14, v44, v47 row_ror:12 row_mask:0xf bank_mask:0x8
    v_add_f32_dpp v15, v48, v51 row_ror:12 row_mask:0xf bank_mask:0x8
    v_add_f32_dpp v12, v37, v12 row_ror:8 row_mask:0xf bank_mask:0x8
    v_add_f32_dpp v13, v41, v13 row_ror:8 row_mask:0xf bank_mask:0x8
    v_add_f32_dpp v14, v45, v14 row_ror:8 row_mask:0xf bank_mask:0x8
    v_add_f32_dpp v15, v49, v15 row_ror:8 row_mask:0xf bank_mask:0x8
    v_add_f32_dpp v12, v38, v12 row_ror:4 row_mask:0xf bank_mask:0x8
    v_add_f32_dpp v13, v42, v13 row_ror:4 row_mask:0xf bank_mask:0x8
    v_add_f32_dpp v14, v46, v14 row_ror:4 row_mask:0xf bank_mask:0x8
    v_add_f32_dpp v15, v50, v15 row_ror:4 row_mask:0xf bank_mask:0x8
    s_waitcnt vmcnt(5)
    s_cbranch_vccnz L_deep_24
    s_waitcnt vmcnt(4)
L_deep_24:
    s_mov_b32 s56, 0x37000
    buffer_load_dwordx4 v[124:127], v2, s[28:31], s56 offen sc1 nt
    s_waitcnt vmcnt(5)
    s_cbranch_vccnz L_deep_25
    s_waitcnt vmcnt(4)
L_deep_25:
    s_mov_b32 s56, 0x38000
    buffer_load_dwordx4 v[128:131], v2, s[28:31], s56 offen sc1 nt
    s_waitcnt vmcnt(5)
    s_cbranch_vccnz L_deep_26
    s_waitcnt vmcnt(4)
L_deep_26:
    s_mov_b32 s56, 0x39000
    buffer_load_dwordx4 v[132:135], v2, s[28:31], s56 offen sc1 nt
    v_mfma_f32_16x16x32_bf16 v[36:39], v[96:99], v[52:55], 0
    v_mfma_f32_16x16x32_bf16 v[40:43], v[100:103], v[52:55], 0
    v_mfma_f32_16x16x32_bf16 v[44:47], v[104:107], v[52:55], 0
    v_mfma_f32_16x16x32_bf16 v[48:51], v[108:111], v[52:55], 0
    s_nop 5
    v_add_f32_dpp v16, v37, v36 row_ror:12 row_mask:0xf bank_mask:0x1
    v_add_f32_dpp v17, v41, v40 row_ror:12 row_mask:0xf bank_mask:0x1
    v_add_f32_dpp v18, v45, v44 row_ror:12 row_mask:0xf bank_mask:0x1
    v_add_f32_dpp v19, v49, v48 row_ror:12 row_mask:0xf bank_mask:0x1
    v_add_f32_dpp v16, v38, v16 row_ror:8 row_mask:0xf bank_mask:0x1
    v_add_f32_dpp v17, v42, v17 row_ror:8 row_mask:0xf bank_mask:0x1
    v_add_f32_dpp v18, v46, v18 row_ror:8 row_mask:0xf bank_mask:0x1
    v_add_f32_dpp v19, v50, v19 row_ror:8 row_mask:0xf bank_mask:0x1
    v_add_f32_dpp v16, v39, v16 row_ror:4 row_mask:0xf bank_mask:0x1
    v_add_f32_dpp v17, v43, v17 row_ror:4 row_mask:0xf bank_mask:0x1
    v_add_f32_dpp v18, v47, v18 row_ror:4 row_mask:0xf bank_mask:0x1
    v_add_f32_dpp v19, v51, v19 row_ror:4 row_mask:0xf bank_mask:0x1
    s_waitcnt vmcnt(5)
    s_cbranch_vccnz L_deep_27
    s_waitcnt vmcnt(4)
L_deep_27:
    s_mov_b32 s56, 0x3a000
    buffer_load_dwordx4 v[136:139], v2, s[28:31], s56 offen sc1 nt
    s_waitcnt vmcnt(5)
    s_cbranch_vccnz L_deep_28
    s_waitcnt vmcnt(4)
L_deep_28:
    s_mov_b32 s56, 0x3b000
    buffer_load_dwordx4 v[140:143], v2, s[28:31], s56 offen sc1 nt
    s_waitcnt vmcnt(5)
    s_cbranch_vccnz L_deep_29
    s_waitcnt vmcnt(4)
L_deep_29:
    s_mov_b32 s56, 0x3c000
    buffer_load_dwordx4 v[144:147], v2, s[28:31], s56 offen sc1 nt
    s_waitcnt vmcnt(5)
    s_cbranch_vccnz L_deep_30
    s_waitcnt vmcnt(4)
L_deep_30:
    s_mov_b32 s56, 0x3d000
    buffer_load_dwordx4 v[148:151], v2, s[28:31], s56 offen sc1 nt
    v_mfma_f32_16x16x32_bf16 v[36:39], v[112:115], v[52:55], 0
    v_mfma_f32_16x16x32_bf16 v[40:43], v[116:119], v[52:55], 0
    v_mfma_f32_16x16x32_bf16 v[44:47], v[120:123], v[52:55], 0
    v_mfma_f32_16x16x32_bf16 v[48:51], v[124:127], v[52:55], 0
    s_nop 5
    v_add_f32_dpp v16, v38, v37 row_ror:12 row_mask:0xf bank_mask:0x2
    v_add_f32_dpp v17, v42, v41 row_ror:12 row_mask:0xf bank_mask:0x2
    v_add_f32_dpp v18, v46, v45 row_ror:12 row_mask:0xf bank_mask:0x2
    v_add_f32_dpp v19, v50, v49 row_ror:12 row_mask:0xf bank_mask:0x2
    v_add_f32_dpp v16, v39, v16 row_ror:8 row_mask:0xf bank_mask:0x2
    v_add_f32_dpp v17, v43, v17 row_ror:8 row_mask:0xf bank_mask:0x2
    v_add_f32_dpp v18, v47, v18 row_ror:8 row_mask:0xf bank_mask:0x2
    v_add_f32_dpp v19, v51, v19 row_ror:8 row_mask:0xf bank_mask:0x2
    v_add_f32_dpp v16, v36, v16 row_ror:4 row_mask:0xf bank_mask:0x2
    v_add_f32_dpp v17, v40, v17 row_ror:4 row_mask:0xf bank_mask:0x2
    v_add_f32_dpp v18, v44, v18 row_ror:4 row_mask:0xf bank_mask:0x2
    v_add_f32_dpp v19, v48, v19 row_ror:4 row_mask:0xf bank_mask:0x2
    s_waitcnt vmcnt(5)
    s_cbranch_vccnz L_deep_31
    s_waitcnt vmcnt(4)
L_deep_31:
    s_mov_b32 s56, 0x3e000
    buffer_load_dwordx4 v[152:155], v2, s[28:31], s56 offen sc1 nt
    s_waitcnt vmcnt(5)
    s_cbranch_vccnz L_deep_32
    s_waitcnt vmcnt(4)
L_deep_32:
    s_mov_b32 s56, 0x3f000
    buffer_load_dwordx4 v[156:159], v2, s[28:31], s56 offen sc1 nt
    s_waitcnt vmcnt(5)
    s_cbranch_vccnz L_deep_33
    s_waitcnt vmcnt(4)
L_deep_33:
    buffer_load_dwordx4 v[160:163], v3, s[32:35], 0 offen sc1 nt
    s_waitcnt vmcnt(5)
    s_cbranch_vccnz L_deep_34
    s_waitcnt vmcnt(4)
L_deep_34:
    s_mov_b32 s56, 0x1000
    buffer_load_dwordx4 v[164:167], v3, s[32:35], s56 offen sc1 nt
    v_mfma_f32_16x16x32_bf16 v[36:39], v[128:131], v[52:55], 0
    v_mfma_f32_16x16x32_bf16 v[40:43], v[132:135], v[52:55], 0
    v_mfma_f32_16x16x32_bf16 v[44:47], v[136:139], v[52:55], 0
    v_mfma_f32_16x16x32_bf16 v[48:51], v[140:143], v[52:55], 0
    s_nop 5
    v_add_f32_dpp v16, v39, v38 row_ror:12 row_mask:0xf bank_mask:0x4
    v_add_f32_dpp v17, v43, v42 row_ror:12 row_mask:0xf bank_mask:0x4
    v_add_f32_dpp v18, v47, v46 row_ror:12 row_mask:0xf bank_mask:0x4
    v_add_f32_dpp v19, v51, v50 row_ror:12 row_mask:0xf bank_mask:0x4
    v_add_f32_dpp v16, v36, v16 row_ror:8 row_mask:0xf bank_mask:0x4
    v_add_f32_dpp v17, v40, v17 row_ror:8 row_mask:0xf bank_mask:0x4
    v_add_f32_dpp v18, v44, v18 row_ror:8 row_mask:0xf bank_mask:0x4
    v_add_f32_dpp v19, v48, v19 row_ror:8 row_mask:0xf bank_mask:0x4
    v_add_f32_dpp v16, v37, v16 row_ror:4 row_mask:0xf bank_mask:0x4
    v_add_f32_dpp v17, v41, v17 row_ror:4 row_mask:0xf bank_mask:0x4
    v_add_f32_dpp v18, v45, v18 row_ror:4 row_mask:0xf bank_mask:0x4
    v_add_f32_dpp v19, v49, v19 row_ror:4 row_mask:0xf bank_mask:0x4
    s_waitcnt vmcnt(5)
    s_cbranch_vccnz L_deep_35
    s_waitcnt vmcnt(4)
L_deep_35:
    s_mov_b32 s56, 0x2000
    buffer_load_dwordx4 v[168:171], v3, s[32:35], s56 offen sc1 nt
    s_waitcnt vmcnt(5)
    s_cbranch_vccnz L_deep_36
    s_waitcnt vmcnt(4)
L_deep_36:
    s_mov_b32 s56, 0x3000
    buffer_load_dwordx4 v[172:175], v3, s[32:35], s56 offen sc1 nt
    s_waitcnt vmcnt(5)
    s_cbranch_vccnz L_deep_37
    s_waitcnt vmcnt(4)
L_deep_37:
    s_mov_b32 s56, 0x4000
    buffer_load_dwordx4 v[176:179], v3, s[32:35], s56 offen sc1 nt
    s_waitcnt vmcnt(5)
    s_cbranch_vccnz L_deep_38
    s_waitcnt vmcnt(4)
L_deep_38:
    s_mov_b32 s56, 0x5000
    buffer_load_dwordx4 v[180:183], v3, s[32:35], s56 offen sc1 nt
    v_mfma_f32_16x16x32_bf16 v[36:39], v[144:147], v[52:55], 0
    v_mfma_f32_16x16x32_bf16 v[40:43], v[148:151], v[52:55], 0
    v_mfma_f32_16x16x32_bf16 v[44:47], v[152:155], v[52:55], 0
    v_mfma_f32_16x16x32_bf16 v[48:51], v[156:159], v[52:55], 0
    s_nop 5
    v_add_f32_dpp v16, v36, v39 row_ror:12 row_mask:0xf bank_mask:0x8
    v_add_f32_dpp v17, v40, v43 row_ror:12 row_mask:0xf bank_mask:0x8
    v_add_f32_dpp v18, v44, v47 row_ror:12 row_mask:0xf bank_mask:0x8
    v_add_f32_dpp v19, v48, v51 row_ror:12 row_mask:0xf bank_mask:0x8
    v_add_f32_dpp v16, v37, v16 row_ror:8 row_mask:0xf bank_mask:0x8
    v_add_f32_dpp v17, v41, v17 row_ror:8 row_mask:0xf bank_mask:0x8
    v_add_f32_dpp v18, v45, v18 row_ror:8 row_mask:0xf bank_mask:0x8
    v_add_f32_dpp v19, v49, v19 row_ror:8 row_mask:0xf bank_mask:0x8
    v_add_f32_dpp v16, v38, v16 row_ror:4 row_mask:0xf bank_mask:0x8
    v_add_f32_dpp v17, v42, v17 row_ror:4 row_mask:0xf bank_mask:0x8
    v_add_f32_dpp v18, v46, v18 row_ror:4 row_mask:0xf bank_mask:0x8
    v_add_f32_dpp v19, v50, v19 row_ror:4 row_mask:0xf bank_mask:0x8
    v_cvt_pk_bf16_f32 v36, v4, v5
    v_cvt_pk_bf16_f32 v37, v6, v7
    v_cvt_pk_bf16_f32 v38, v8, v9
    v_cvt_pk_bf16_f32 v39, v10, v11
    v_cvt_pk_bf16_f32 v40, v12, v13
    v_cvt_pk_bf16_f32 v41, v14, v15
    v_cvt_pk_bf16_f32 v42, v16, v17
    v_cvt_pk_bf16_f32 v43, v18, v19
    v_lshlrev_b32 v4, 16, v36
    v_and_b32 v5, 0xffff0000, v36
    v_lshlrev_b32 v6, 16, v37
    v_and_b32 v7, 0xffff0000, v37
    v_lshlrev_b32 v8, 16, v38
    v_and_b32 v9, 0xffff0000, v38
    v_lshlrev_b32 v10, 16, v39
    v_and_b32 v11, 0xffff0000, v39
    v_lshlrev_b32 v12, 16, v40
    v_and_b32 v13, 0xffff0000, v40
    v_lshlrev_b32 v14, 16, v41
    v_and_b32 v15, 0xffff0000, v41
    v_lshlrev_b32 v16, 16, v42
    v_and_b32 v17, 0xffff0000, v42
    v_lshlrev_b32 v18, 16, v43
    v_and_b32 v19, 0xffff0000, v43
    s_waitcnt vmcnt(5)
    s_cbranch_vccnz L_deep_39
    s_waitcnt vmcnt(4)
L_deep_39:
    s_mov_b32 s56, 0x6000
    buffer_load_dwordx4 v[184:187], v3, s[32:35], s56 offen sc1 nt
    v_mul_f32 v4, 0x3db504f3, v4
    v_mul_f32 v5, 0x3db504f3, v5
    v_mul_f32 v6, 0x3db504f3, v6
    v_mul_f32 v7, 0x3db504f3, v7
    v_mul_f32 v8, 0x3db504f3, v8
    v_mul_f32 v9, 0x3db504f3, v9
    v_mul_f32 v10, 0x3db504f3, v10
    v_mul_f32 v11, 0x3db504f3, v11
    v_mul_f32 v12, 0x3db504f3, v12
    v_mul_f32 v13, 0x3db504f3, v13
    v_mul_f32 v14, 0x3db504f3, v14
    v_mul_f32 v15, 0x3db504f3, v15
    v_mul_f32 v16, 0x3db504f3, v16
    v_mul_f32 v17, 0x3db504f3, v17
    v_mul_f32 v18, 0x3db504f3, v18
    v_mul_f32 v19, 0x3db504f3, v19
    v_cvt_pk_bf16_f32 v36, v4, v5
    v_cvt_pk_bf16_f32 v37, v6, v7
    v_cvt_pk_bf16_f32 v38, v8, v9
    v_cvt_pk_bf16_f32 v39, v10, v11
    v_cvt_pk_bf16_f32 v40, v12, v13
    v_cvt_pk_bf16_f32 v41, v14, v15
    v_cvt_pk_bf16_f32 v42, v16, v17
    v_cvt_pk_bf16_f32 v43, v18, v19
    v_lshlrev_b32 v4, 16, v36
    v_and_b32 v5, 0xffff0000, v36
    v_lshlrev_b32 v6, 16, v37
    v_and_b32 v7, 0xffff0000, v37
    v_lshlrev_b32 v8, 16, v38
    v_and_b32 v9, 0xffff0000, v38
    v_lshlrev_b32 v10, 16, v39
    v_and_b32 v11, 0xffff0000, v39
    v_lshlrev_b32 v12, 16, v40
    v_and_b32 v13, 0xffff0000, v40
    v_lshlrev_b32 v14, 16, v41
    v_and_b32 v15, 0xffff0000, v41
    v_lshlrev_b32 v16, 16, v42
    v_and_b32 v17, 0xffff0000, v42
    v_lshlrev_b32 v18, 16, v43
    v_and_b32 v19, 0xffff0000, v43
    s_waitcnt vmcnt(5)
    s_cbranch_vccnz L_deep_40
    s_waitcnt vmcnt(4)
L_deep_40:
    s_mov_b32 s56, 0x7000
    buffer_load_dwordx4 v[188:191], v3, s[32:35], s56 offen sc1 nt
    v_max3_f32 v60, v4, v5, v6
    v_max3_f32 v61, v7, v8, v9
    v_max3_f32 v60, v60, v10, v11
    v_max_f32 v60, v60, v61
    v_max3_f32 v62, v12, v13, v14
    v_max3_f32 v61, v15, v16, v17
    v_max3_f32 v62, v62, v18, v19
    v_max_f32 v62, v62, v61
    v_max_f32 v60, v60, v62
    s_nop 1
    v_max_f32_dpp v60, v60, v60 row_ror:8 row_mask:0xf bank_mask:0xf
    s_nop 1
    v_max_f32_dpp v60, v60, v60 row_ror:4 row_mask:0xf bank_mask:0xf
    v_mov_b32 v61, v60
    s_nop 1
    v_permlane16_swap_b32 v60, v61
    v_max_f32 v60, v60, v61
    v_mov_b32 v61, v60
    s_nop 1
    v_permlane32_swap_b32 v60, v61
    v_max_f32 v60, v60, v61
    ds_write_b32 v67, v60 offset:3072
    s_waitcnt vmcnt(5)
    s_cbranch_vccnz L_deep_41
    s_waitcnt vmcnt(4)
L_deep_41:
    s_mov_b32 s56, 0x8000
    buffer_load_dwordx4 v[192:195], v3, s[32:35], s56 offen sc1 nt
    s_waitcnt lgkmcnt(0)
    s_barrier
    ds_read_b128 v[36:39], v66 offset:3072
    s_waitcnt lgkmcnt(0)
    v_max3_f32 v60, v36, v37, v38
    v_max_f32 v60, v60, v39
    v_mul_f32 v60, s62, v60
    v_fma_f32 v4, v4, s62, -v60
    v_fma_f32 v5, v5, s62, -v60
    v_fma_f32 v6, v6, s62, -v60
    v_fma_f32 v7, v7, s62, -v60
    v_fma_f32 v8, v8, s62, -v60
    v_fma_f32 v9, v9, s62, -v60
    v_fma_f32 v10, v10, s62, -v60
    v_fma_f32 v11, v11, s62, -v60
    v_fma_f32 v12, v12, s62, -v60
    v_fma_f32 v13, v13, s62, -v60
    v_fma_f32 v14, v14, s62, -v60
    v_fma_f32 v15, v15, s62, -v60
    v_fma_f32 v16, v16, s62, -v60
    v_fma_f32 v17, v17, s62, -v60
    v_fma_f32 v18, v18, s62, -v60
    v_fma_f32 v19, v19, s62, -v60
    s_waitcnt vmcnt(5)
    s_cbranch_vccnz L_deep_42
    s_waitcnt vmcnt(4)
L_deep_42:
    s_mov_b32 s56, 0x9000
    buffer_load_dwordx4 v[196:199], v3, s[32:35], s56 offen sc1 nt
    v_exp_f32 v4, v4
    v_exp_f32 v5, v5
    v_exp_f32 v6, v6
    v_exp_f32 v7, v7
    v_exp_f32 v8, v8
    v_exp_f32 v9, v9
    v_exp_f32 v10, v10
    v_exp_f32 v11, v11
    v_exp_f32 v12, v12
    v_exp_f32 v13, v13
    v_exp_f32 v14, v14
    v_exp_f32 v15, v15
    v_exp_f32 v16, v16
    v_exp_f32 v17, v17
    v_exp_f32 v18, v18
    v_exp_f32 v19, v19
    s_waitcnt vmcnt(5)
    s_cbranch_vccnz L_deep_43
    s_waitcnt vmcnt(4)
L_deep_43:
    s_mov_b32 s56, 0xa000
    buffer_load_dwordx4 v[200:203], v3, s[32:35], s56 offen sc1 nt
    v_cvt_pk_bf16_f32 v52, v4, v5
    v_cvt_pk_bf16_f32 v53, v6, v7
    v_cvt_pk_bf16_f32 v54, v8, v9
    v_cvt_pk_bf16_f32 v55, v10, v11
    v_cvt_pk_bf16_f32 v56, v12, v13
    v_cvt_pk_bf16_f32 v57, v14, v15
    v_cvt_pk_bf16_f32 v58, v16, v17
    v_cvt_pk_bf16_f32 v59, v18, v19
    v_add_f32 v4, v4, v12
    v_add_f32 v5, v5, v13
    v_add_f32 v6, v6, v14
    v_add_f32 v7, v7, v15
    v_add_f32 v8, v8, v16
    v_add_f32 v9, v9, v17
    v_add_f32 v10, v10, v18
    v_add_f32 v11, v11, v19
    v_add_f32 v4, v4, v8
    v_add_f32 v5, v5, v9
    v_add_f32 v6, v6, v10
    v_add_f32 v7, v7, v11
    v_add_f32 v4, v4, v6
    v_add_f32 v5, v5, v7
    v_add_f32 v60, v4, v5
    s_nop 1
    v_add_f32_dpp v60, v60, v60 row_ror:8 row_mask:0xf bank_mask:0xf
    s_nop 1
    v_add_f32_dpp v60, v60, v60 row_ror:4 row_mask:0xf bank_mask:0xf
    v_mov_b32 v61, v60
    s_nop 1
    v_permlane16_swap_b32 v60, v61
    v_add_f32 v60, v60, v61
    v_mov_b32 v61, v60
    s_nop 1
    v_permlane32_swap_b32 v60, v61
    v_add_f32 v60, v60, v61
    ds_write_b32 v67, v60 offset:3200
    s_waitcnt vmcnt(5)
    s_cbranch_vccnz L_deep_44
    s_waitcnt vmcnt(4)
L_deep_44:
    s_mov_b32 s56, 0xb000
    buffer_load_dwordx4 v[204:207], v3, s[32:35], s56 offen sc1 nt
    s_waitcnt lgkmcnt(0)
    s_barrier
    s_waitcnt vmcnt(5)
    s_cbranch_vccnz L_deep_45
    s_waitcnt vmcnt(4)
L_deep_45:
    s_mov_b32 s56, 0xc000
    buffer_load_dwordx4 v[208:211], v3, s[32:35], s56 offen sc1 nt
    v_perm_b32 v36, v164, v160, s60
    v_perm_b32 v38, v164, v160, s61
    v_perm_b32 v40, v165, v161, s60
    v_perm_b32 v42, v165, v161, s61
    v_perm_b32 v44, v166, v162, s60
    v_perm_b32 v46, v166, v162, s61
    v_perm_b32 v48, v167, v163, s60
    v_perm_b32 v50, v167, v163, s61
    v_perm_b32 v37, v172, v168, s60
    v_perm_b32 v39, v172, v168, s61
    v_perm_b32 v41, v173, v169, s60
    v_perm_b32 v43, v173, v169, s61
    v_perm_b32 v45, v174, v170, s60
    v_perm_b32 v47, v174, v170, s61
    v_perm_b32 v49, v175, v171, s60
    v_perm_b32 v51, v175, v171, s61
    v_mfma_f32_4x4x4_16b_bf16 v[4:7], v[52:53], v[36:37], 0 cbsz:2 abid:0
    v_mfma_f32_4x4x4_16b_bf16 v[8:11], v[52:53], v[38:39], 0 cbsz:2 abid:0
    v_mfma_f32_4x4x4_16b_bf16 v[12:15], v[52:53], v[40:41], 0 cbsz:2 abid:0
    v_mfma_f32_4x4x4_16b_bf16 v[16:19], v[52:53], v[42:43], 0 cbsz:2 abid:0
    v_mfma_f32_4x4x4_16b_bf16 v[20:23], v[52:53], v[44:45], 0 cbsz:2 abid:0
    v_mfma_f32_4x4x4_16b_bf16 v[24:27], v[52:53], v[46:47], 0 cbsz:2 abid:0
    v_mfma_f32_4x4x4_16b_bf16 v[28:31], v[52:53], v[48:49], 0 cbsz:2 abid:0
    v_mfma_f32_4x4x4_16b_bf16 v[32:35], v[52:53], v[50:51], 0 cbsz:2 abid:0
    s_waitcnt vmcnt(5)
    s_cbranch_vccnz L_deep_46
    s_waitcnt vmcnt(4)
L_deep_46:
    s_mov_b32 s56, 0xd000
    buffer_load_dwordx4 v[212:215], v3, s[32:35], s56 offen sc1 nt
    v_perm_b32 v36, v180, v176, s60
    v_perm_b32 v38, v180, v176, s61
    v_perm_b32 v40, v181, v177, s60
    v_perm_b32 v42, v181, v177, s61
    v_perm_b32 v44, v182, v178, s60
    v_perm_b32 v46, v182, v178, s61
    v_perm_b32 v48, v183, v179, s60
    v_perm_b32 v50, v183, v179, s61
    v_perm_b32 v37, v188, v184, s60
    v_perm_b32 v39, v188, v184, s61
    v_perm_b32 v41, v189, v185, s60
    v_perm_b32 v43, v189, v185, s61
    v_perm_b32 v45, v190, v186, s60
    v_perm_b32 v47, v190, v186, s61
    v_perm_b32 v49, v191, v187, s60
    v_perm_b32 v51, v191, v187, s61
    v_mfma_f32_4x4x4_16b_bf16 v[4:7], v[52:53], v[36:37], v[4:7] cbsz:2 abid:1
    v_mfma_f32_4x4x4_16b_bf16 v[8:11], v[52:53], v[38:39], v[8:11] cbsz:2 abid:1
    v_mfma_f32_4x4x4_16b_bf16 v[12:15], v[52:53], v[40:41], v[12:15] cbsz:2 abid:1
    v_mfma_f32_4x4x4_16b_bf16 v[16:19], v[52:53], v[42:43], v[16:19] cbsz:2 abid:1
    v_mfma_f32_4x4x4_16b_bf16 v[20:23], v[52:53], v[44:45], v[20:23] cbsz:2 abid:1
    v_mfma_f32_4x4x4_16b_bf16 v[24:27], v[52:53], v[46:47], v[24:27] cbsz:2 abid:1
    v_mfma_f32_4x4x4_16b_bf16 v[28:31], v[52:53], v[48:49], v[28:31] cbsz:2 abid:1
    v_mfma_f32_4x4x4_16b_bf16 v[32:35], v[52:53], v[50:51], v[32:35] cbsz:2 abid:1
    s_waitcnt vmcnt(5)
    s_cbranch_vccnz L_deep_47
    s_waitcnt vmcnt(4)
L_deep_47:
    s_mov_b32 s56, 0xe000
    buffer_load_dwordx4 v[216:219], v3, s[32:35], s56 offen sc1 nt
    s_waitcnt vmcnt(5)
    s_cbranch_vccnz L_deep_48
    s_waitcnt vmcnt(4)
L_deep_48:
    s_mov_b32 s56, 0xf000
    buffer_load_dwordx4 v[220:223], v3, s[32:35], s56 offen sc1 nt
    s_waitcnt vmcnt(5)
    s_cbranch_vccnz L_deep_49
    s_waitcnt vmcnt(4)
L_deep_49:
    s_mov_b32 s56, 0x10000
    buffer_load_dwordx4 v[224:227], v3, s[32:35], s56 offen sc1 nt
    s_waitcnt vmcnt(5)
    s_cbranch_vccnz L_deep_50
    s_waitcnt vmcnt(4)
L_deep_50:
    s_mov_b32 s56, 0x11000
    buffer_load_dwordx4 v[228:231], v3, s[32:35], s56 offen sc1 nt
    v_perm_b32 v36, v196, v192, s60
    v_perm_b32 v38, v196, v192, s61
    v_perm_b32 v40, v197, v193, s60
    v_perm_b32 v42, v197, v193, s61
    v_perm_b32 v44, v198, v194, s60
    v_perm_b32 v46, v198, v194, s61
    v_perm_b32 v48, v199, v195, s60
    v_perm_b32 v50, v199, v195, s61
    v_perm_b32 v37, v204, v200, s60
    v_perm_b32 v39, v204, v200, s61
    v_perm_b32 v41, v205, v201, s60
    v_perm_b32 v43, v205, v201, s61
    v_perm_b32 v45, v206, v202, s60
    v_perm_b32 v47, v206, v202, s61
    v_perm_b32 v49, v207, v203, s60
    v_perm_b32 v51, v207, v203, s61
    v_mfma_f32_4x4x4_16b_bf16 v[4:7], v[52:53], v[36:37], v[4:7] cbsz:2 abid:2
    v_mfma_f32_4x4x4_16b_bf16 v[8:11], v[52:53], v[38:39], v[8:11] cbsz:2 abid:2
    v_mfma_f32_4x4x4_16b_bf16 v[12:15], v[52:53], v[40:41], v[12:15] cbsz:2 abid:2
    v_mfma_f32_4x4x4_16b_bf16 v[16:19], v[52:53], v[42:43], v[16:19] cbsz:2 abid:2
    v_mfma_f32_4x4x4_16b_bf16 v[20:23], v[52:53], v[44:45], v[20:23] cbsz:2 abid:2
    v_mfma_f32_4x4x4_16b_bf16 v[24:27], v[52:53], v[46:47], v[24:27] cbsz:2 abid:2
    v_mfma_f32_4x4x4_16b_bf16 v[28:31], v[52:53], v[48:49], v[28:31] cbsz:2 abid:2
    v_mfma_f32_4x4x4_16b_bf16 v[32:35], v[52:53], v[50:51], v[32:35] cbsz:2 abid:2
    s_waitcnt vmcnt(5)
    s_cbranch_vccnz L_deep_51
    s_waitcnt vmcnt(4)
L_deep_51:
    ds_read_b32 v78, v79
    s_mov_b32 s56, 0x12000
    buffer_load_dwordx4 v[232:235], v3, s[32:35], s56 offen sc1 nt
    s_waitcnt vmcnt(5)
    s_cbranch_vccnz L_deep_52
    s_waitcnt vmcnt(4)
L_deep_52:
    s_waitcnt lgkmcnt(0)
    v_cmp_ne_u32 vcc, 0, v78
    s_mov_b32 s56, 0x13000
    buffer_load_dwordx4 v[236:239], v3, s[32:35], s56 offen sc1 nt
    s_waitcnt vmcnt(5)
    s_cbranch_vccnz L_deep_53
    s_waitcnt vmcnt(4)
L_deep_53:
    s_mov_b32 s56, 0x14000
    buffer_load_dwordx4 v[240:243], v3, s[32:35], s56 offen sc1 nt
    s_waitcnt vmcnt(5)
    s_cbranch_vccnz L_deep_54
    s_waitcnt vmcnt(4)
L_deep_54:
    s_mov_b32 s56, 0x15000
    buffer_load_dwordx4 v[244:247], v3, s[32:35], s56 offen sc1 nt
    v_perm_b32 v36, v212, v208, s60
    v_perm_b32 v38, v212, v208, s61
    v_perm_b32 v40, v213, v209, s60
    v_perm_b32 v42, v213, v209, s61
    v_perm_b32 v44, v214, v210, s60
    v_perm_b32 v46, v214, v210, s61
    v_perm_b32 v48, v215, v211, s60
    v_perm_b32 v50, v215, v211, s61
    v_perm_b32 v37, v220, v216, s60
    v_perm_b32 v39, v220, v216, s61
    v_perm_b32 v41, v221, v217, s60
    v_perm_b32 v43, v221, v217, s61
    v_perm_b32 v45, v222, v218, s60
    v_perm_b32 v47, v222, v218, s61
    v_perm_b32 v49, v223, v219, s60
    v_perm_b32 v51, v223, v219, s61
    v_mfma_f32_4x4x4_16b_bf16 v[4:7], v[52:53], v[36:37], v[4:7] cbsz:2 abid:3
    v_mfma_f32_4x4x4_16b_bf16 v[8:11], v[52:53], v[38:39], v[8:11] cbsz:2 abid:3
    v_mfma_f32_4x4x4_16b_bf16 v[12:15], v[52:53], v[40:41], v[12:15] cbsz:2 abid:3
    v_mfma_f32_4x4x4_16b_bf16 v[16:19], v[52:53], v[42:43], v[16:19] cbsz:2 abid:3
    v_mfma_f32_4x4x4_16b_bf16 v[20:23], v[52:53], v[44:45], v[20:23] cbsz:2 abid:3
    v_mfma_f32_4x4x4_16b_bf16 v[24:27], v[52:53], v[46:47], v[24:27] cbsz:2 abid:3
    v_mfma_f32_4x4x4_16b_bf16 v[28:31], v[52:53], v[48:49], v[28:31] cbsz:2 abid:3
    v_mfma_f32_4x4x4_16b_bf16 v[32:35], v[52:53], v[50:51], v[32:35] cbsz:2 abid:3
    s_waitcnt vmcnt(5)
    s_cbranch_vccnz L_deep_55
    s_waitcnt vmcnt(4)
L_deep_55:
    s_mov_b32 s56, 0x16000
    buffer_load_dwordx4 v[248:251], v3, s[32:35], s56 offen sc1 nt
    s_waitcnt vmcnt(5)
    s_cbranch_vccnz L_deep_56
    s_waitcnt vmcnt(4)
L_deep_56:
    s_mov_b32 s56, 0x17000
    buffer_load_dwordx4 v[252:255], v3, s[32:35], s56 offen sc1 nt
    s_waitcnt vmcnt(5)
    s_cbranch_vccnz L_deep_57
    s_waitcnt vmcnt(4)
L_deep_57:
    s_mov_b32 s56, 0x18000
    buffer_load_dwordx4 v[80:83], v3, s[32:35], s56 offen sc1 nt
    s_waitcnt vmcnt(5)
    s_cbranch_vccnz L_deep_58
    s_waitcnt vmcnt(4)
L_deep_58:
    s_mov_b32 s56, 0x19000
    buffer_load_dwordx4 v[84:87], v3, s[32:35], s56 offen sc1 nt
    v_perm_b32 v36, v228, v224, s60
    v_perm_b32 v38, v228, v224, s61
    v_perm_b32 v40, v229, v225, s60
    v_perm_b32 v42, v229, v225, s61
    v_perm_b32 v44, v230, v226, s60
    v_perm_b32 v46, v230, v226, s61
    v_perm_b32 v48, v231, v227, s60
    v_perm_b32 v50, v231, v227, s61
    v_perm_b32 v37, v236, v232, s60
    v_perm_b32 v39, v236, v232, s61
    v_perm_b32 v41, v237, v233, s60
    v_perm_b32 v43, v237, v233, s61
    v_perm_b32 v45, v238, v234, s60
    v_perm_b32 v47, v238, v234, s61
    v_perm_b32 v49, v239, v235, s60
    v_perm_b32 v51, v239, v235, s61
    v_mfma_f32_4x4x4_16b_bf16 v[4:7], v[54:55], v[36:37], v[4:7] cbsz:2 abid:0
    v_mfma_f32_4x4x4_16b_bf16 v[8:11], v[54:55], v[38:39], v[8:11] cbsz:2 abid:0
    v_mfma_f32_4x4x4_16b_bf16 v[12:15], v[54:55], v[40:41], v[12:15] cbsz:2 abid:0
    v_mfma_f32_4x4x4_16b_bf16 v[16:19], v[54:55], v[42:43], v[16:19] cbsz:2 abid:0
    v_mfma_f32_4x4x4_16b_bf16 v[20:23], v[54:55], v[44:45], v[20:23] cbsz:2 abid:0
    v_mfma_f32_4x4x4_16b_bf16 v[24:27], v[54:55], v[46:47], v[24:27] cbsz:2 abid:0
    v_mfma_f32_4x4x4_16b_bf16 v[28:31], v[54:55], v[48:49], v[28:31] cbsz:2 abid:0
    v_mfma_f32_4x4x4_16b_bf16 v[32:35], v[54:55], v[50:51], v[32:35] cbsz:2 abid:0
    s_waitcnt vmcnt(5)
    s_cbranch_vccnz L_deep_59
    s_waitcnt vmcnt(4)
L_deep_59:
    s_mov_b32 s56, 0x1a000
    buffer_load_dwordx4 v[88:91], v3, s[32:35], s56 offen sc1 nt
    s_waitcnt vmcnt(5)
    s_cbranch_vccnz L_deep_60
    s_waitcnt vmcnt(4)
L_deep_60:
    s_mov_b32 s56, 0x1b000
    buffer_load_dwordx4 v[92:95], v3, s[32:35], s56 offen sc1 nt
    s_waitcnt vmcnt(5)
    s_cbranch_vccnz L_deep_61
    s_waitcnt vmcnt(4)
L_deep_61:
    s_mov_b32 s56, 0x1c000
    buffer_load_dwordx4 v[96:99], v3, s[32:35], s56 offen sc1 nt
    s_waitcnt vmcnt(5)
    s_cbranch_vccnz L_deep_62
    s_waitcnt vmcnt(4)
L_deep_62:
    s_mov_b32 s56, 0x1d000
    buffer_load_dwordx4 v[100:103], v3, s[32:35], s56 offen sc1 nt
    v_perm_b32 v36, v244, v240, s60
    v_perm_b32 v38, v244, v240, s61
    v_perm_b32 v40, v245, v241, s60
    v_perm_b32 v42, v245, v241, s61
    v_perm_b32 v44, v246, v242, s60
    v_perm_b32 v46, v246, v242, s61
    v_perm_b32 v48, v247, v243, s60
    v_perm_b32 v50, v247, v243, s61
    v_perm_b32 v37, v252, v248, s60
    v_perm_b32 v39, v252, v248, s61
    v_perm_b32 v41, v253, v249, s60
    v_perm_b32 v43, v253, v249, s61
    v_perm_b32 v45, v254, v250, s60
    v_perm_b32 v47, v254, v250, s61
    v_perm_b32 v49, v255, v251, s60
    v_perm_b32 v51, v255, v251, s61
    v_mfma_f32_4x4x4_16b_bf16 v[4:7], v[54:55], v[36:37], v[4:7] cbsz:2 abid:1
    v_mfma_f32_4x4x4_16b_bf16 v[8:11], v[54:55], v[38:39], v[8:11] cbsz:2 abid:1
    v_mfma_f32_4x4x4_16b_bf16 v[12:15], v[54:55], v[40:41], v[12:15] cbsz:2 abid:1
    v_mfma_f32_4x4x4_16b_bf16 v[16:19], v[54:55], v[42:43], v[16:19] cbsz:2 abid:1
    v_mfma_f32_4x4x4_16b_bf16 v[20:23], v[54:55], v[44:45], v[20:23] cbsz:2 abid:1
    v_mfma_f32_4x4x4_16b_bf16 v[24:27], v[54:55], v[46:47], v[24:27] cbsz:2 abid:1
    v_mfma_f32_4x4x4_16b_bf16 v[28:31], v[54:55], v[48:49], v[28:31] cbsz:2 abid:1
    v_mfma_f32_4x4x4_16b_bf16 v[32:35], v[54:55], v[50:51], v[32:35] cbsz:2 abid:1
    s_waitcnt vmcnt(5)
    s_cbranch_vccnz L_deep_63
    s_waitcnt vmcnt(4)
L_deep_63:
    s_mov_b32 s56, 0x1e000
    buffer_load_dwordx4 v[104:107], v3, s[32:35], s56 offen sc1 nt
    s_waitcnt vmcnt(5)
    s_cbranch_vccnz L_deep_64
    s_waitcnt vmcnt(4)
L_deep_64:
    s_mov_b32 s56, 0x1f000
    buffer_load_dwordx4 v[108:111], v3, s[32:35], s56 offen sc1 nt
    s_waitcnt vmcnt(5)
    s_cbranch_vccnz L_deep_65
    s_waitcnt vmcnt(4)
L_deep_65:
    s_mov_b32 s56, 0x20000
    buffer_load_dwordx4 v[112:115], v3, s[32:35], s56 offen sc1 nt
    s_waitcnt vmcnt(5)
    s_cbranch_vccnz L_deep_66
    s_waitcnt vmcnt(4)
L_deep_66:
    s_mov_b32 s56, 0x21000
    buffer_load_dwordx4 v[116:119], v3, s[32:35], s56 offen sc1 nt
    v_perm_b32 v36, v84, v80, s60
    v_perm_b32 v38, v84, v80, s61
    v_perm_b32 v40, v85, v81, s60
    v_perm_b32 v42, v85, v81, s61
    v_perm_b32 v44, v86, v82, s60
    v_perm_b32 v46, v86, v82, s61
    v_perm_b32 v48, v87, v83, s60
    v_perm_b32 v50, v87, v83, s61
    v_perm_b32 v37, v92, v88, s60
    v_perm_b32 v39, v92, v88, s61
    v_perm_b32 v41, v93, v89, s60
    v_perm_b32 v43, v93, v89, s61
    v_perm_b32 v45, v94, v90, s60
    v_perm_b32 v47, v94, v90, s61
    v_perm_b32 v49, v95, v91, s60
    v_perm_b32 v51, v95, v91, s61
    v_mfma_f32_4x4x4_16b_bf16 v[4:7], v[54:55], v[36:37], v[4:7] cbsz:2 abid:2
    v_mfma_f32_4x4x4_16b_bf16 v[8:11], v[54:55], v[38:39], v[8:11] cbsz:2 abid:2
    v_mfma_f32_4x4x4_16b_bf16 v[12:15], v[54:55], v[40:41], v[12:15] cbsz:2 abid:2
    v_mfma_f32_4x4x4_16b_bf16 v[16:19], v[54:55], v[42:43], v[16:19] cbsz:2 abid:2
    v_mfma_f32_4x4x4_16b_bf16 v[20:23], v[54:55], v[44:45], v[20:23] cbsz:2 abid:2
    v_mfma_f32_4x4x4_16b_bf16 v[24:27], v[54:55], v[46:47], v[24:27] cbsz:2 abid:2
    v_mfma_f32_4x4x4_16b_bf16 v[28:31], v[54:55], v[48:49], v[28:31] cbsz:2 abid:2
    v_mfma_f32_4x4x4_16b_bf16 v[32:35], v[54:55], v[50:51], v[32:35] cbsz:2 abid:2
    s_waitcnt vmcnt(5)
    s_cbranch_vccnz L_deep_67
    s_waitcnt vmcnt(4)
L_deep_67:
    s_mov_b32 s56, 0x22000
    buffer_load_dwordx4 v[120:123], v3, s[32:35], s56 offen sc1 nt
    s_waitcnt vmcnt(5)
    s_cbranch_vccnz L_deep_68
    s_waitcnt vmcnt(4)
L_deep_68:
    s_mov_b32 s56, 0x23000
    buffer_load_dwordx4 v[124:127], v3, s[32:35], s56 offen sc1 nt
    s_waitcnt vmcnt(5)
    s_cbranch_vccnz L_deep_69
    s_waitcnt vmcnt(4)
L_deep_69:
    s_mov_b32 s56, 0x24000
    buffer_load_dwordx4 v[128:131], v3, s[32:35], s56 offen sc1 nt
    s_waitcnt vmcnt(5)
    s_cbranch_vccnz L_deep_70
    s_waitcnt vmcnt(4)
L_deep_70:
    s_mov_b32 s56, 0x25000
    buffer_load_dwordx4 v[132:135], v3, s[32:35], s56 offen sc1 nt
    v_perm_b32 v36, v100, v96, s60
    v_perm_b32 v38, v100, v96, s61
    v_perm_b32 v40, v101, v97, s60
    v_perm_b32 v42, v101, v97, s61
    v_perm_b32 v44, v102, v98, s60
    v_perm_b32 v46, v102, v98, s61
    v_perm_b32 v48, v103, v99, s60
    v_perm_b32 v50, v103, v99, s61
    v_perm_b32 v37, v108, v104, s60
    v_perm_b32 v39, v108, v104, s61
    v_perm_b32 v41, v109, v105, s60
    v_perm_b32 v43, v109, v105, s61
    v_perm_b32 v45, v110, v106, s60
    v_perm_b32 v47, v110, v106, s61
    v_perm_b32 v49, v111, v107, s60
    v_perm_b32 v51, v111, v107, s61
    v_mfma_f32_4x4x4_16b_bf16 v[4:7], v[54:55], v[36:37], v[4:7] cbsz:2 abid:3
    v_mfma_f32_4x4x4_16b_bf16 v[8:11], v[54:55], v[38:39], v[8:11] cbsz:2 abid:3
    v_mfma_f32_4x4x4_16b_bf16 v[12:15], v[54:55], v[40:41], v[12:15] cbsz:2 abid:3
    v_mfma_f32_4x4x4_16b_bf16 v[16:19], v[54:55], v[42:43], v[16:19] cbsz:2 abid:3
    v_mfma_f32_4x4x4_16b_bf16 v[20:23], v[54:55], v[44:45], v[20:23] cbsz:2 abid:3
    v_mfma_f32_4x4x4_16b_bf16 v[24:27], v[54:55], v[46:47], v[24:27] cbsz:2 abid:3
    v_mfma_f32_4x4x4_16b_bf16 v[28:31], v[54:55], v[48:49], v[28:31] cbsz:2 abid:3
    v_mfma_f32_4x4x4_16b_bf16 v[32:35], v[54:55], v[50:51], v[32:35] cbsz:2 abid:3
    s_mov_b32 s56, 0x26000
    buffer_load_dwordx4 v[136:139], v3, s[32:35], s56 offen sc1 nt
    s_mov_b32 s56, 0x27000
    buffer_load_dwordx4 v[140:143], v3, s[32:35], s56 offen sc1 nt
    s_cbranch_vccnz L_deep_71
    s_waitcnt vmcnt(7)
L_deep_71:
    s_mov_b32 s56, 0x28000
    buffer_load_dwordx4 v[144:147], v3, s[32:35], s56 offen sc1 nt
    s_waitcnt vmcnt(8)
    s_cbranch_vccnz L_deep_72
    s_waitcnt vmcnt(7)
L_deep_72:
    s_mov_b32 s56, 0x29000
    buffer_load_dwordx4 v[148:151], v3, s[32:35], s56 offen sc1 nt
    s_waitcnt vmcnt(8)
    s_cbranch_vccnz L_deep_73
    s_waitcnt vmcnt(7)
L_deep_73:
    s_mov_b32 s56, 0x2a000
    buffer_load_dwordx4 v[152:155], v3, s[32:35], s56 offen sc1 nt
    s_waitcnt vmcnt(8)
    s_cbranch_vccnz L_deep_74
    s_waitcnt vmcnt(7)
L_deep_74:
    s_mov_b32 s56, 0x2b000
    buffer_load_dwordx4 v[156:159], v3, s[32:35], s56 offen sc1 nt
    s_barrier
    s_waitcnt vmcnt(8)
    s_cbranch_vccnz L_deep_75
    s_waitcnt vmcnt(7)
L_deep_75:
    s_mov_b32 s56, 0x2c000
    buffer_load_dwordx4 v[160:163], v3, s[32:35], s56 offen sc1 nt
    v_perm_b32 v36, v116, v112, s60
    v_perm_b32 v38, v116, v112, s61
    v_perm_b32 v40, v117, v113, s60
    v_perm_b32 v42, v117, v113, s61
    v_perm_b32 v44, v118, v114, s60
    v_perm_b32 v46, v118, v114, s61
    v_perm_b32 v48, v119, v115, s60
    v_perm_b32 v50, v119, v115, s61
    v_perm_b32 v37, v124, v120, s60
    v_perm_b32 v39, v124, v120, s61
    v_perm_b32 v41, v125, v121, s60
    v_perm_b32 v43, v125, v121, s61
    v_perm_b32 v45, v126, v122, s60
    v_perm_b32 v47, v126, v122, s61
    v_perm_b32 v49, v127, v123, s60
    v_perm_b32 v51, v127, v123, s61
    v_mfma_f32_4x4x4_16b_bf16 v[4:7], v[56:57], v[36:37], v[4:7] cbsz:2 abid:0
    v_mfma_f32_4x4x4_16b_bf16 v[8:11], v[56:57], v[38:39], v[8:11] cbsz:2 abid:0
    v_mfma_f32_4x4x4_16b_bf16 v[12:15], v[56:57], v[40:41], v[12:15] cbsz:2 abid:0
    v_mfma_f32_4x4x4_16b_bf16 v[16:19], v[56:57], v[42:43], v[16:19] cbsz:2 abid:0
    v_mfma_f32_4x4x4_16b_bf16 v[20:23], v[56:57], v[44:45], v[20:23] cbsz:2 abid:0
    v_mfma_f32_4x4x4_16b_bf16 v[24:27], v[56:57], v[46:47], v[24:27] cbsz:2 abid:0
    v_mfma_f32_4x4x4_16b_bf16 v[28:31], v[56:57], v[48:49], v[28:31] cbsz:2 abid:0
    v_mfma_f32_4x4x4_16b_bf16 v[32:35], v[56:57], v[50:51], v[32:35] cbsz:2 abid:0
    s_waitcnt vmcnt(8)
    s_cbranch_vccnz L_deep_76
    s_waitcnt vmcnt(7)
L_deep_76:
    s_mov_b32 s56, 0x2d000
    buffer_load_dwordx4 v[164:167], v3, s[32:35], s56 offen sc1 nt
    s_waitcnt vmcnt(8)
    s_cbranch_vccnz L_deep_77
    s_waitcnt vmcnt(7)
L_deep_77:
    s_mov_b32 s56, 0x2e000
    buffer_load_dwordx4 v[168:171], v3, s[32:35], s56 offen sc1 nt
    s_waitcnt vmcnt(8)
    s_cbranch_vccnz L_deep_78
    s_waitcnt vmcnt(7)
L_deep_78:
    s_mov_b32 s56, 0x2f000
    buffer_load_dwordx4 v[172:175], v3, s[32:35], s56 offen sc1 nt
    s_waitcnt vmcnt(8)
    s_cbranch_vccnz L_deep_79
    s_waitcnt vmcnt(7)
L_deep_79:
    s_mov_b32 s56, 0x30000
    buffer_load_dwordx4 v[176:179], v3, s[32:35], s56 offen sc1 nt
    v_perm_b32 v36, v132, v128, s60
    v_perm_b32 v38, v132, v128, s61
    v_perm_b32 v40, v133, v129, s60
    v_perm_b32 v42, v133, v129, s61
    v_perm_b32 v44, v134, v130, s60
    v_perm_b32 v46, v134, v130, s61
    v_perm_b32 v48, v135, v131, s60
    v_perm_b32 v50, v135, v131, s61
    v_perm_b32 v37, v140, v136, s60
    v_perm_b32 v39, v140, v136, s61
    v_perm_b32 v41, v141, v137, s60
    v_perm_b32 v43, v141, v137, s61
    v_perm_b32 v45, v142, v138, s60
    v_perm_b32 v47, v142, v138, s61
    v_perm_b32 v49, v143, v139, s60
    v_perm_b32 v51, v143, v139, s61
    v_mfma_f32_4x4x4_16b_bf16 v[4:7], v[56:57], v[36:37], v[4:7] cbsz:2 abid:1
    v_mfma_f32_4x4x4_16b_bf16 v[8:11], v[56:57], v[38:39], v[8:11] cbsz:2 abid:1
    v_mfma_f32_4x4x4_16b_bf16 v[12:15], v[56:57], v[40:41], v[12:15] cbsz:2 abid:1
    v_mfma_f32_4x4x4_16b_bf16 v[16:19], v[56:57], v[42:43], v[16:19] cbsz:2 abid:1
    v_mfma_f32_4x4x4_16b_bf16 v[20:23], v[56:57], v[44:45], v[20:23] cbsz:2 abid:1
    v_mfma_f32_4x4x4_16b_bf16 v[24:27], v[56:57], v[46:47], v[24:27] cbsz:2 abid:1
    v_mfma_f32_4x4x4_16b_bf16 v[28:31], v[56:57], v[48:49], v[28:31] cbsz:2 abid:1
    v_mfma_f32_4x4x4_16b_bf16 v[32:35], v[56:57], v[50:51], v[32:35] cbsz:2 abid:1
    s_waitcnt vmcnt(8)
    s_cbranch_vccnz L_deep_80
    s_waitcnt vmcnt(7)
L_deep_80:
    s_mov_b32 s56, 0x31000
    buffer_load_dwordx4 v[180:183], v3, s[32:35], s56 offen sc1 nt
    s_waitcnt vmcnt(8)
    s_cbranch_vccnz L_deep_81
    s_waitcnt vmcnt(7)
L_deep_81:
    ds_read_b32 v78, v79
    s_mov_b32 s56, 0x32000
    buffer_load_dwordx4 v[184:187], v3, s[32:35], s56 offen sc1 nt
    s_waitcnt vmcnt(8)
    s_cbranch_vccnz L_deep_82
    s_waitcnt vmcnt(7)
L_deep_82:
    s_waitcnt lgkmcnt(0)
    v_cmp_ne_u32 vcc, 0, v78
    s_mov_b32 s56, 0x33000
    buffer_load_dwordx4 v[188:191], v3, s[32:35], s56 offen sc1 nt
    s_waitcnt vmcnt(8)
    s_cbranch_vccnz L_deep_83
    s_waitcnt vmcnt(7)
L_deep_83:
    s_mov_b32 s56, 0x34000
    buffer_load_dwordx4 v[192:195], v3, s[32:35], s56 offen sc1 nt
    v_perm_b32 v36, v148, v144, s60
    v_perm_b32 v38, v148, v144, s61
    v_perm_b32 v40, v149, v145, s60
    v_perm_b32 v42, v149, v145, s61
    v_perm_b32 v44, v150, v146, s60
    v_perm_b32 v46, v150, v146, s61
    v_perm_b32 v48, v151, v147, s60
    v_perm_b32 v50, v151, v147, s61
    v_perm_b32 v37, v156, v152, s60
    v_perm_b32 v39, v156, v152, s61
    v_perm_b32 v41, v157, v153, s60
    v_perm_b32 v43, v157, v153, s61
    v_perm_b32 v45, v158, v154, s60
    v_perm_b32 v47, v158, v154, s61
    v_perm_b32 v49, v159, v155, s60
    v_perm_b32 v51, v159, v155, s61
    v_mfma_f32_4x4x4_16b_bf16 v[4:7], v[56:57], v[36:37], v[4:7] cbsz:2 abid:2
    v_mfma_f32_4x4x4_16b_bf16 v[8:11], v[56:57], v[38:39], v[8:11] cbsz:2 abid:2
    v_mfma_f32_4x4x4_16b_bf16 v[12:15], v[56:57], v[40:41], v[12:15] cbsz:2 abid:2
    v_mfma_f32_4x4x4_16b_bf16 v[16:19], v[56:57], v[42:43], v[16:19] cbsz:2 abid:2
    v_mfma_f32_4x4x4_16b_bf16 v[20:23], v[56:57], v[44:45], v[20:23] cbsz:2 abid:2
    v_mfma_f32_4x4x4_16b_bf16 v[24:27], v[56:57], v[46:47], v[24:27] cbsz:2 abid:2
    v_mfma_f32_4x4x4_16b_bf16 v[28:31], v[56:57], v[48:49], v[28:31] cbsz:2 abid:2
    v_mfma_f32_4x4x4_16b_bf16 v[32:35], v[56:57], v[50:51], v[32:35] cbsz:2 abid:2
    s_waitcnt vmcnt(8)
    s_cbranch_vccnz L_deep_84
    s_waitcnt vmcnt(7)
L_deep_84:
    s_mov_b32 s56, 0x35000
    buffer_load_dwordx4 v[196:199], v3, s[32:35], s56 offen sc1 nt
    s_waitcnt vmcnt(8)
    s_cbranch_vccnz L_deep_85
    s_waitcnt vmcnt(7)
L_deep_85:
    s_mov_b32 s56, 0x36000
    buffer_load_dwordx4 v[200:203], v3, s[32:35], s56 offen sc1 nt
    s_waitcnt vmcnt(8)
    s_cbranch_vccnz L_deep_86
    s_waitcnt vmcnt(7)
L_deep_86:
    s_mov_b32 s56, 0x37000
    buffer_load_dwordx4 v[204:207], v3, s[32:35], s56 offen sc1 nt
    s_waitcnt vmcnt(8)
    s_cbranch_vccnz L_deep_87
    s_waitcnt vmcnt(7)
L_deep_87:
    s_mov_b32 s56, 0x38000
    buffer_load_dwordx4 v[208:211], v3, s[32:35], s56 offen sc1 nt
    v_perm_b32 v36, v164, v160, s60
    v_perm_b32 v38, v164, v160, s61
    v_perm_b32 v40, v165, v161, s60
    v_perm_b32 v42, v165, v161, s61
    v_perm_b32 v44, v166, v162, s60
    v_perm_b32 v46, v166, v162, s61
    v_perm_b32 v48, v167, v163, s60
    v_perm_b32 v50, v167, v163, s61
    v_perm_b32 v37, v172, v168, s60
    v_perm_b32 v39, v172, v168, s61
    v_perm_b32 v41, v173, v169, s60
    v_perm_b32 v43, v173, v169, s61
    v_perm_b32 v45, v174, v170, s60
    v_perm_b32 v47, v174, v170, s61
    v_perm_b32 v49, v175, v171, s60
    v_perm_b32 v51, v175, v171, s61
    v_mfma_f32_4x4x4_16b_bf16 v[4:7], v[56:57], v[36:37], v[4:7] cbsz:2 abid:3
    v_mfma_f32_4x4x4_16b_bf16 v[8:11], v[56:57], v[38:39], v[8:11] cbsz:2 abid:3
    v_mfma_f32_4x4x4_16b_bf16 v[12:15], v[56:57], v[40:41], v[12:15] cbsz:2 abid:3
    v_mfma_f32_4x4x4_16b_bf16 v[16:19], v[56:57], v[42:43], v[16:19] cbsz:2 abid:3
    v_mfma_f32_4x4x4_16b_bf16 v[20:23], v[56:57], v[44:45], v[20:23] cbsz:2 abid:3
    v_mfma_f32_4x4x4_16b_bf16 v[24:27], v[56:57], v[46:47], v[24:27] cbsz:2 abid:3
    v_mfma_f32_4x4x4_16b_bf16 v[28:31], v[56:57], v[48:49], v[28:31] cbsz:2 abid:3
    v_mfma_f32_4x4x4_16b_bf16 v[32:35], v[56:57], v[50:51], v[32:35] cbsz:2 abid:3
    s_waitcnt vmcnt(8)
    s_cbranch_vccnz L_deep_88
    s_waitcnt vmcnt(7)
L_deep_88:
    s_mov_b32 s56, 0x39000
    buffer_load_dwordx4 v[212:215], v3, s[32:35], s56 offen sc1 nt
    s_waitcnt vmcnt(8)
    s_cbranch_vccnz L_deep_89
    s_waitcnt vmcnt(7)
L_deep_89:
    s_mov_b32 s56, 0x3a000
    buffer_load_dwordx4 v[216:219], v3, s[32:35], s56 offen sc1 nt
    s_waitcnt vmcnt(8)
    s_cbranch_vccnz L_deep_90
    s_waitcnt vmcnt(7)
L_deep_90:
    s_mov_b32 s56, 0x3b000
    buffer_load_dwordx4 v[220:223], v3, s[32:35], s56 offen sc1 nt
    s_waitcnt vmcnt(8)
    s_cbranch_vccnz L_deep_91
    s_waitcnt vmcnt(7)
L_deep_91:
    s_mov_b32 s56, 0x3c000
    buffer_load_dwordx4 v[224:227], v3, s[32:35], s56 offen sc1 nt
    v_perm_b32 v36, v180, v176, s60
    v_perm_b32 v38, v180, v176, s61
    v_perm_b32 v40, v181, v177, s60
    v_perm_b32 v42, v181, v177, s61
    v_perm_b32 v44, v182, v178, s60
    v_perm_b32 v46, v182, v178, s61
    v_perm_b32 v48, v183, v179, s60
    v_perm_b32 v50, v183, v179, s61
    v_perm_b32 v37, v188, v184, s60
    v_perm_b32 v39, v188, v184, s61
    v_perm_b32 v41, v189, v185, s60
    v_perm_b32 v43, v189, v185, s61
    v_perm_b32 v45, v190, v186, s60
    v_perm_b32 v47, v190, v186, s61
    v_perm_b32 v49, v191, v187, s60
    v_perm_b32 v51, v191, v187, s61
    v_mfma_f32_4x4x4_16b_bf16 v[4:7], v[58:59], v[36:37], v[4:7] cbsz:2 abid:0
    v_mfma_f32_4x4x4_16b_bf16 v[8:11], v[58:59], v[38:39], v[8:11] cbsz:2 abid:0
    v_mfma_f32_4x4x4_16b_bf16 v[12:15], v[58:59], v[40:41], v[12:15] cbsz:2 abid:0
    v_mfma_f32_4x4x4_16b_bf16 v[16:19], v[58:59], v[42:43], v[16:19] cbsz:2 abid:0
    v_mfma_f32_4x4x4_16b_bf16 v[20:23], v[58:59], v[44:45], v[20:23] cbsz:2 abid:0
    v_mfma_f32_4x4x4_16b_bf16 v[24:27], v[58:59], v[46:47], v[24:27] cbsz:2 abid:0
    v_mfma_f32_4x4x4_16b_bf16 v[28:31], v[58:59], v[48:49], v[28:31] cbsz:2 abid:0
    v_mfma_f32_4x4x4_16b_bf16 v[32:35], v[58:59], v[50:51], v[32:35] cbsz:2 abid:0
    s_waitcnt vmcnt(8)
    s_cbranch_vccnz L_deep_92
    s_waitcnt vmcnt(7)
L_deep_92:
    s_mov_b32 s56, 0x3d000
    buffer_load_dwordx4 v[228:231], v3, s[32:35], s56 offen sc1 nt
    s_waitcnt vmcnt(8)
    s_cbranch_vccnz L_deep_93
    s_waitcnt vmcnt(7)
L_deep_93:
    s_mov_b32 s56, 0x3e000
    buffer_load_dwordx4 v[232:235], v3, s[32:35], s56 offen sc1 nt
    s_waitcnt vmcnt(8)
    s_cbranch_vccnz L_deep_94
    s_waitcnt vmcnt(7)
L_deep_94:
    s_mov_b32 s56, 0x3f000
    buffer_load_dwordx4 v[236:239], v3, s[32:35], s56 offen sc1 nt
    s_barrier
L_Z2:
    s_mov_b64 s[44:45], s[22:23]
    s_mov_b32 s46, 0x400
    s_mov_b32 s47, 0x20000
    s_mov_b32 s64, 0x07060500
    s_mov_b32 s65, 0x0c0c0400
    s_mov_b32 s66, 0x04000c0c
    v_and_b32 v63, 3, v1
    v_lshlrev_b32 v60, 3, v63
    v_lshrrev_b32 v74, v60, s55
    v_lshrrev_b32 v60, 4, v0
    v_lshlrev_b32 v75, 2, v60
    v_mov_b32 v65, 5244
    v_lshrrev_b32 v60, 4, v1
    v_and_b32 v61, 15, v1
    v_lshl_add_u32 v62, v61, 2, v60
    s_lshl_b32 s57, s54, 11
    s_add_u32 s57, s57, 5376
    v_lshl_add_u32 v68, v62, 2, s57
    s_mul_i32 s57, s54, 144
    v_lshl_add_u32 v67, v62, 1, s57
    v_and_b32 v62, 7, v1
    v_mul_u32_u24 v62, 144, v62
    v_lshl_add_u32 v66, v60, 4, v62
    v_lshlrev_b32 v60, 9, v60
    v_bfe_u32 v62, v1, 2, 2
    v_lshl_add_u32 v60, v62, 6, v60
    v_lshl_add_u32 v60, v63, 3, v60
    s_and_b32 s59, s54, 3
    s_lshl_b32 s57, s59, 12
    v_add_u32 v73, s57, v60
    v_lshrrev_b32 v60, 7, v0
    v_lshlrev_b32 v60, 9, v60
    v_and_b32 v62, 1, v0
    v_lshl_add_u32 v60, v62, 8, v60
    v_bfe_u32 v62, v0, 1, 6
    v_lshl_add_u32 v69, v62, 2, v60
    v_add_u32 v69, 5376, v69
    s_lshl_b32 s58, s52, 16
    s_add_u32 s58, s58, 0x60000
    s_lshl_b32 s57, s54, 13
    s_add_u32 s57, s57, s58
    s_lshl_b32 s63, s53, 8
    s_add_u32 s57, s57, s63
    v_lshl_add_u32 v70, v1, 2, s57
    s_lshr_b32 s63, s53, 2
    s_lshl_b32 s57, s63, 13
    s_add_u32 s57, s57, s58
    v_lshl_add_u32 v71, v0, 4, s57
    s_and_b32 s57, s53, 3
    s_lshl_b32 s57, s57, 2
    s_add_u32 s57, s57, s59
    s_lshl_b32 s57, s57, 6
    s_lshl_b32 s58, s52, 3
    s_add_u32 s57, s57, s58
    s_add_u32 s57, s57, s63
    s_lshl_b32 s57, s57, 7
    s_add_u32 s57, s57, 0x40000
    v_lshrrev_b32 v60, 5, v1
    v_lshlrev_b32 v60, 29, v60
    v_lshl_add_u32 v60, v1, 2, v60
    v_add_u32 v72, s57, v60
    v_mov_b32 v64, s55
    ds_read_b32 v75, v75 offset:3312
    ds_read_b32 v65, v65
    s_waitcnt lgkmcnt(0)
    v_readfirstlane_b32 s67, v65
    s_cmp_ge_u32 s54, 4
    s_cbranch_scc1 L_D
    v_mov_b32 v52, 0
    v_mov_b32 v53, 0
    v_mov_b32 v54, 0
    v_mov_b32 v55, 0
    v_mov_b32 v56, 0
    v_mov_b32 v57, 0
    v_mov_b32 v76, 0
    v_mov_b32 v77, 0
    v_perm_b32 v36, v196, v192, s60
    v_perm_b32 v38, v196, v192, s61
    v_perm_b32 v40, v197, v193, s60
    v_perm_b32 v42, v197, v193, s61
    v_perm_b32 v44, v198, v194, s60
    v_perm_b32 v46, v198, v194, s61
    v_perm_b32 v48, v199, v195, s60
    v_perm_b32 v50, v199, v195, s61
    s_waitcnt vmcnt(8)
    v_perm_b32 v37, v204, v200, s60
    v_perm_b32 v39, v204, v200, s61
    v_perm_b32 v41, v205, v201, s60
    v_perm_b32 v43, v205, v201, s61
    v_perm_b32 v45, v206, v202, s60
    v_perm_b32 v47, v206, v202, s61
    v_perm_b32 v49, v207, v203, s60
    v_perm_b32 v51, v207, v203, s61
    v_mfma_f32_4x4x4_16b_bf16 v[4:7], v[58:59], v[36:37], v[4:7] cbsz:2 abid:1
    v_mfma_f32_4x4x4_16b_bf16 v[8:11], v[58:59], v[38:39], v[8:11] cbsz:2 abid:1
    v_mfma_f32_4x4x4_16b_bf16 v[12:15], v[58:59], v[40:41], v[12:15] cbsz:2 abid:1
    v_mfma_f32_4x4x4_16b_bf16 v[16:19], v[58:59], v[42:43], v[16:19] cbsz:2 abid:1
    v_mfma_f32_4x4x4_16b_bf16 v[20:23], v[58:59], v[44:45], v[20:23] cbsz:2 abid:1
    v_mfma_f32_4x4x4_16b_bf16 v[24:27], v[58:59], v[46:47], v[24:27] cbsz:2 abid:1
    v_mfma_f32_4x4x4_16b_bf16 v[28:31], v[58:59], v[48:49], v[28:31] cbsz:2 abid:1
    v_mfma_f32_4x4x4_16b_bf16 v[32:35], v[58:59], v[50:51], v[32:35] cbsz:2 abid:1
    s_waitcnt vmcnt(6)
    v_perm_b32 v36, v212, v208, s60
    v_perm_b32 v38, v212, v208, s61
    v_perm_b32 v40, v213, v209, s60
    v_perm_b32 v42, v213, v209, s61
    v_perm_b32 v44, v214, v210, s60
    v_perm_b32 v46, v214, v210, s61
    v_perm_b32 v48, v215, v211, s60
    v_perm_b32 v50, v215, v211, s61
    s_waitcnt vmcnt(4)
    v_perm_b32 v37, v220, v216, s60
    v_perm_b32 v39, v220, v216, s61
    v_perm_b32 v41, v221, v217, s60
    v_perm_b32 v43, v221, v217, s61
    v_perm_b32 v45, v222, v218, s60
    v_perm_b32 v47, v222, v218, s61
    v_perm_b32 v49, v223, v219, s60
    v_perm_b32 v51, v223, v219, s61
    v_mfma_f32_4x4x4_16b_bf16 v[4:7], v[58:59], v[36:37], v[4:7] cbsz:2 abid:2
    v_mfma_f32_4x4x4_16b_bf16 v[8:11], v[58:59], v[38:39], v[8:11] cbsz:2 abid:2
    v_mfma_f32_4x4x4_16b_bf16 v[12:15], v[58:59], v[40:41], v[12:15] cbsz:2 abid:2
    v_mfma_f32_4x4x4_16b_bf16 v[16:19], v[58:59], v[42:43], v[16:19] cbsz:2 abid:2
    v_mfma_f32_4x4x4_16b_bf16 v[20:23], v[58:59], v[44:45], v[20:23] cbsz:2 abid:2
    v_mfma_f32_4x4x4_16b_bf16 v[24:27], v[58:59], v[46:47], v[24:27] cbsz:2 abid:2
    v_mfma_f32_4x4x4_16b_bf16 v[28:31], v[58:59], v[48:49], v[28:31] cbsz:2 abid:2
    v_mfma_f32_4x4x4_16b_bf16 v[32:35], v[58:59], v[50:51], v[32:35] cbsz:2 abid:2
    v_mov_b32_dpp v52, v58 row_ror:4 row_mask:0xf bank_mask:0x1
    v_mov_b32_dpp v53, v59 row_ror:4 row_mask:0xf bank_mask:0x1
    v_mov_b32_dpp v54, v58 row_ror:8 row_mask:0xf bank_mask:0x2
    v_mov_b32_dpp v55, v59 row_ror:8 row_mask:0xf bank_mask:0x2
    v_mov_b32_dpp v56, v58 row_ror:12 row_mask:0xf bank_mask:0x4
    v_mov_b32_dpp v57, v59 row_ror:12 row_mask:0xf bank_mask:0x4
    v_mov_b32_dpp v76, v58 quad_perm:[0,1,2,3] row_mask:0xf bank_mask:0x8
    v_mov_b32_dpp v77, v59 quad_perm:[0,1,2,3] row_mask:0xf bank_mask:0x8
    v_permlane32_swap_b32 v4, v20
    v_permlane32_swap_b32 v5, v21
    v_permlane32_swap_b32 v6, v22
    v_permlane32_swap_b32 v7, v23
    v_permlane32_swap_b32 v8, v24
    v_permlane32_swap_b32 v9, v25
    v_permlane32_swap_b32 v10, v26
    v_permlane32_swap_b32 v11, v27
    v_permlane32_swap_b32 v12, v28
    v_permlane32_swap_b32 v13, v29
    v_permlane32_swap_b32 v14, v30
    v_permlane32_swap_b32 v15, v31
    v_permlane32_swap_b32 v16, v32
    v_permlane32_swap_b32 v17, v33
    v_permlane32_swap_b32 v18, v34
    v_permlane32_swap_b32 v19, v35
    v_add_f32 v4, v4, v20
    v_add_f32 v5, v5, v21
    v_add_f32 v6, v6, v22
    v_add_f32 v7, v7, v23
    v_add_f32 v8, v8, v24
    v_add_f32 v9, v9, v25
    v_add_f32 v10, v10, v26
    v_add_f32 v11, v11, v27
    v_add_f32 v12, v12, v28
    v_add_f32 v13, v13, v29
    v_add_f32 v14, v14, v30
    v_add_f32 v15, v15, v31
    v_add_f32 v16, v16, v32
    v_add_f32 v17, v17, v33
    v_add_f32 v18, v18, v34
    v_add_f32 v19, v19, v35
    v_permlane16_swap_b32 v4, v12
    v_permlane16_swap_b32 v5, v13
    v_permlane16_swap_b32 v6, v14
    v_permlane16_swap_b32 v7, v15
    v_permlane16_swap_b32 v8, v16
    v_permlane16_swap_b32 v9, v17
    v_permlane16_swap_b32 v10, v18
    v_permlane16_swap_b32 v11, v19
    v_add_f32 v20, v4, v12
    v_add_f32 v21, v5, v13
    v_add_f32 v22, v6, v14
    v_add_f32 v23, v7, v15
    v_add_f32 v24, v8, v16
    v_add_f32 v25, v9, v17
    v_add_f32 v26, v10, v18
    v_add_f32 v27, v11, v19
    s_waitcnt vmcnt(2)
    v_perm_b32 v36, v228, v224, s60
    v_perm_b32 v38, v228, v224, s61
    v_perm_b32 v40, v229, v225, s60
    v_perm_b32 v42, v229, v225, s61
    v_perm_b32 v44, v230, v226, s60
    v_perm_b32 v46, v230, v226, s61
    v_perm_b32 v48, v231, v227, s60
    v_perm_b32 v50, v231, v227, s61
    s_waitcnt vmcnt(0)
    v_perm_b32 v37, v236, v232, s60
    v_perm_b32 v39, v236, v232, s61
    v_perm_b32 v41, v237, v233, s60
    v_perm_b32 v43, v237, v233, s61
    v_perm_b32 v45, v238, v234, s60
    v_perm_b32 v47, v238, v234, s61
    v_perm_b32 v49, v239, v235, s60
    v_perm_b32 v51, v239, v235, s61
    v_mfma_f32_16x16x16_bf16 v[20:23], v[52:53], v[36:37], v[20:23]
    v_mfma_f32_16x16x16_bf16 v[24:27], v[52:53], v[38:39], v[24:27]
    v_mfma_f32_16x16x16_bf16 v[20:23], v[54:55], v[40:41], v[20:23]
    v_mfma_f32_16x16x16_bf16 v[24:27], v[54:55], v[42:43], v[24:27]
    v_mfma_f32_16x16x16_bf16 v[20:23], v[56:57], v[44:45], v[20:23]
    v_mfma_f32_16x16x16_bf16 v[24:27], v[56:57], v[46:47], v[24:27]
    v_mfma_f32_16x16x16_bf16 v[20:23], v[76:77], v[48:49], v[20:23]
    v_mfma_f32_16x16x16_bf16 v[24:27], v[76:77], v[50:51], v[24:27]
    s_nop 7
    ds_write2st64_b32 v68, v20, v24 offset0:0 offset1:1
    ds_write2st64_b32 v68, v21, v25 offset0:2 offset1:3
    ds_write2st64_b32 v68, v22, v26 offset0:4 offset1:5
    ds_write2st64_b32 v68, v23, v27 offset0:6 offset1:7
L_D:
    s_waitcnt lgkmcnt(0)
    s_barrier
    ds_read2st64_b32 v[36:37], v69 offset0:0 offset1:8
    ds_read2st64_b32 v[38:39], v69 offset0:16 offset1:24
    s_cmp_eq_u32 s67, 1
    s_waitcnt lgkmcnt(0)
    v_add_f32 v36, v36, v38
    v_add_f32 v37, v37, v39
    v_add_f32 v60, v36, v37
    v_perm_b32 v60, v60, v74, s64
    s_cbranch_scc0 L_far
    buffer_store_dword v60, v70, s[48:51], 0 offen
L_near:
    buffer_load_dwordx4 v[96:99], v71, s[48:51], 0 offen sc1
    s_waitcnt vmcnt(0)
    ds_read_b64_tr_b16 v[80:81], v73 offset:21760
    ds_read_b64_tr_b16 v[82:83], v73 offset:22016
    ds_read_b64_tr_b16 v[84:85], v73 offset:23808
    ds_read_b64_tr_b16 v[86:87], v73 offset:24064
    ds_read_b64_tr_b16 v[88:89], v73 offset:21792
    ds_read_b64_tr_b16 v[90:91], v73 offset:22048
    ds_read_b64_tr_b16 v[92:93], v73 offset:23840
    ds_read_b64_tr_b16 v[94:95], v73 offset:24096
    s_mov_b32 s63, 200000
    v_perm_b32 v61, v97, v96, s65
    v_perm_b32 v62, v99, v98, s66
    v_bitop3_b32 v63, v61, v62, v64 bitop3:0x56
    v_cmp_ne_u32 vcc, 0, v63
    s_cbranch_vccz L_done_96
L_again_95:
    buffer_load_dwordx4 v[96:99], v71, s[48:51], 0 offen sc1
    s_sub_u32 s63, s63, 1
    s_waitcnt vmcnt(0)
    s_cbranch_scc1 L_done_96
    v_perm_b32 v61, v97, v96, s65
    v_perm_b32 v62, v99, v98, s66
    v_bitop3_b32 v63, v61, v62, v64 bitop3:0x56
    v_cmp_ne_u32 vcc, 0, v63
    s_cbranch_vccnz L_again_95
L_done_96:
    v_and_b32 v96, 0xffffff00, v96
    v_and_b32 v97, 0xffffff00, v97
    v_and_b32 v98, 0xffffff00, v98
    v_and_b32 v99, 0xffffff00, v99
    v_mul_f32 v96, v96, v75
    v_mul_f32 v97, v97, v75
    v_mul_f32 v98, v98, v75
    v_mul_f32 v99, v99, v75
    s_nop 1
    v_permlane32_swap_b32 v96, v98
    v_permlane32_swap_b32 v97, v99
    v_add_f32 v96, v96, v98
    v_add_f32 v97, v97, v99
    s_nop 1
    v_permlane16_swap_b32 v96, v97
    v_add_f32 v96, v96, v97
    v_cvt_pk_bf16_f32 v96, v96, v96
    ds_write_b16 v67, v96 offset:1024
    s_waitcnt lgkmcnt(0)
    s_barrier
    s_cmp_lt_u32 s54, 4
    s_cbranch_scc1 L_hop2
    ds_read_b128 v[36:39], v66 offset:1024
    ds_read_b128 v[40:43], v66 offset:1088
    s_waitcnt lgkmcnt(1)
    v_mfma_f32_16x16x32_bf16 v[44:47], v[36:39], v[80:83], 0
    v_mfma_f32_16x16x32_bf16 v[48:51], v[36:39], v[88:91], 0
    s_waitcnt lgkmcnt(0)
    v_mfma_f32_16x16x32_bf16 v[44:47], v[40:43], v[84:87], v[44:47]
    v_mfma_f32_16x16x32_bf16 v[48:51], v[40:43], v[92:95], v[48:51]
    s_nop 6
    v_add_f32 v44, v44, v45
    v_add_f32 v46, v46, v47
    v_add_f32 v48, v48, v49
    v_add_f32 v50, v50, v51
    v_add_f32 v44, v44, v46
    v_add_f32 v48, v48, v50
    s_nop 1
    v_permlane16_swap_b32 v44, v48
    v_add_f32 v60, v44, v48
    v_perm_b32 v60, v60, v74, s64
    buffer_store_dword v60, v72, s[48:51], 0 offen sc1
L_hop2:
    s_cmp_ge_u32 s2, 16
    s_cbranch_scc1 L_exit
    s_lshl_b32 s57, s2, 13
    s_add_u32 s57, s57, 0x40000
    s_lshl_b32 s58, s54, 10
    s_add_u32 s57, s57, s58
    v_lshl_add_u32 v68, v1, 3, s57
    v_mov_b32 v120, 0
    v_mov_b32 v121, 0
    v_mov_b32 v122, 0
    v_mov_b32 v123, 0
    buffer_atomic_or_x2 v[120:121], v68, s[48:51], 0 offen offset:0 sc0 sc1
    buffer_atomic_or_x2 v[122:123], v68, s[48:51], 0 offen offset:512 sc0 sc1
    v_mov_b32 v69, s55
    v_and_b32 v61, 1, v1
    v_lshlrev_b32 v61, 4, v61
    v_lshrrev_b32 v61, v61, s55
    v_and_b32 v61, 0xffff, v61
    v_lshl_or_b32 v67, v61, 16, v61
    v_and_b32 v61, 15, v1
    v_lshlrev_b32 v61, 6, v61
    v_lshrrev_b32 v62, 5, v1
    v_lshlrev_b32 v62, 5, v62
    s_lshl_b32 s57, s54, 2
    v_add3_u32 v70, v61, v62, s57
    v_and_b32 v61, 31, v1
    v_lshlrev_b32 v71, 5, v61
    v_lshlrev_b32 v62, 2, v61
    ds_read_b32 v72, v62 offset:3440
    ds_read_b32 v73, v62 offset:3568
    s_lshl_b32 s57, s2, 6
    v_lshl_add_u32 v75, v61, 1, s57
    v_mov_b32 v65, 5236
    v_mov_b32 v66, 1
    s_waitcnt vmcnt(0)
    s_mov_b32 s63, 200000
    v_perm_b32 v61, v121, v120, s65
    v_perm_b32 v62, v123, v122, s66
    v_bitop3_b32 v63, v61, v62, v67 bitop3:0x56
    v_cmp_ne_u32 vcc, 0, v63
    s_cbranch_vccz L_done_98
L_again_97:
    v_mov_b32 v120, 0
    v_mov_b32 v121, 0
    v_mov_b32 v122, 0
    v_mov_b32 v123, 0
    buffer_atomic_or_x2 v[120:121], v68, s[48:51], 0 offen offset:0 sc0 sc1
    buffer_atomic_or_x2 v[122:123], v68, s[48:51], 0 offen offset:512 sc0 sc1
    s_sub_u32 s63, s63, 1
    s_waitcnt vmcnt(0)
    s_cbranch_scc1 L_done_98
    v_perm_b32 v61, v121, v120, s65
    v_perm_b32 v62, v123, v122, s66
    v_bitop3_b32 v63, v61, v62, v67 bitop3:0x56
    v_cmp_ne_u32 vcc, 0, v63
    s_cbranch_vccnz L_again_97
L_done_98:
    v_and_b32 v120, 0xffffff00, v120
    v_and_b32 v121, 0xffffff00, v121
    v_and_b32 v122, 0xffffff00, v122
    v_and_b32 v123, 0xffffff00, v123
    v_add_f32 v120, v120, v122
    v_add_f32 v121, v121, v123
    s_nop 1
    v_permlane32_swap_b32 v120, v121
    v_add_f32 v120, v120, v121
    v_mov_b32 v121, v120
    s_nop 1
    v_permlane16_swap_b32 v120, v121
    v_add_f32 v120, v120, v121
    ds_write_b32 v70, v120 offset:4208
    s_mov_b64 exec, 1
    ds_add_rtn_u32 v66, v65, v66
    s_mov_b32 exec_lo, -1
    ds_read_b128 v[36:39], v71 offset:4208
    ds_read_b128 v[40:43], v71 offset:4224
    s_waitcnt lgkmcnt(0)
    v_readfirstlane_b32 s57, v66
    v_add_f32 v36, v36, v40
    v_add_f32 v37, v37, v41
    v_add_f32 v38, v38, v42
    v_add_f32 v39, v39, v43
    v_add_f32 v36, v36, v38
    v_add_f32 v37, v37, v39
    v_add_f32 v60, v36, v37
    s_cmp_lg_u32 s57, 7
    s_cbranch_scc1 L_exit0
    v_cvt_pk_bf16_f32 v60, v60, v60
    v_and_b32 v60, 0xffff0000, v60
    v_mul_f32 v60, v60, v72
    v_cvt_pk_bf16_f32 v60, v60, v60
    v_and_b32 v60, 0xffff0000, v60
    v_add_f32 v60, v60, v73
    v_cvt_pk_bf16_f32 v60, v60, v60
    buffer_store_short v60, v75, s[44:47], 0 offen
    s_mov_b64 exec, -1
    s_cmp_lg_u32 s2, 0
    s_cbranch_scc1 L_exit
    v_mov_b32 v60, 0xe0000
    s_mov_b64 exec, 1
    buffer_store_dword v69, v60, s[48:51], 0 offen sc1
    s_mov_b64 exec, -1
    s_branch L_exit
L_far:
    buffer_store_dword v60, v70, s[48:51], 0 offen sc1
    s_branch L_near
L_Z:
    s_mov_b64 s[40:41], s[12:13]
    s_mov_b32 s42, 0x400000
    s_mov_b32 s43, 0x20000
    s_lshl_b32 s57, s52, 19
    s_lshr_b32 s58, s53, 2
    s_lshl_b32 s58, s58, 16
    s_add_u32 s57, s57, s58
    s_and_b32 s58, s53, 3
    s_lshl_b32 s58, s58, 8
    s_add_u32 s57, s57, s58
    s_and_b32 s59, s54, 3
    s_lshl_b32 s58, s59, 6
    s_add_u32 s57, s57, s58
    v_lshrrev_b32 v60, 2, v1
    v_lshlrev_b32 v60, 10, v60
    v_and_b32 v61, 3, v1
    v_lshlrev_b32 v61, 4, v61
    v_add3_u32 v60, v60, v61, s57
    s_lshl_b32 s59, s59, 12
    s_add_u32 m0, s59, 21760
    s_barrier
    buffer_load_dwordx4 v60, s[40:43], 0 offen offset:0 nt lds
    s_mov_b32 s56, 15360
    buffer_load_dwordx4 v60, s[40:43], s56 offen offset:1024 nt lds
    s_mov_b32 s56, 30720
    buffer_load_dwordx4 v60, s[40:43], s56 offen offset:2048 nt lds
    s_mov_b32 s56, 46080
    buffer_load_dwordx4 v60, s[40:43], s56 offen offset:3072 nt lds
    s_branch L_Z2
L_helper:
    s_waitcnt lgkmcnt(0)
    s_load_dword s55, s[26:27], 0xe0000
    s_mov_b64 s[48:49], s[26:27]
    s_mov_b32 s50, 0x10000000
    s_mov_b32 s51, 0x20000
    s_mov_b64 s[36:37], s[4:5]
    s_mov_b32 s38, 0x400
    s_mov_b32 s39, 0x20000
    s_cmp_ge_u32 s54, 6
    s_cbranch_scc1 L_h23
    s_and_b32 s60, s53, 3
    s_lshr_b32 s61, s53, 2
    s_cmp_eq_u32 s54, 4
    s_cbranch_scc0 L_h1_setup
    s_lshl_b32 s3, s52, 13
    s_lshl_b32 s57, s60, 11
    s_add_u32 s3, s3, s57
    s_add_u32 s3, s3, 0x0
    s_branch L_tile
L_h1_setup:
    s_cmp_ge_u32 s53, 28
    s_cbranch_scc1 L_h23
    s_lshl_b32 s61, s61, 3
    s_add_u32 s61, s61, s52
    s_sub_u32 s57, s61, 28
    s_cmp_ge_u32 s61, 28
    s_cselect_b32 s61, s57, s61
    s_cselect_b32 s3, 0x7000, 0
    s_add_u32 s3, s3, 0x10000
    s_mul_i32 s57, s60, 7168
    s_add_u32 s3, s3, s57
L_tile:
    v_lshlrev_b32 v4, 4, v1
    buffer_load_dwordx4 v[16:19], v4, s[36:39], 0 offen
    s_lshl_b32 s57, s61, 8
    s_add_u32 s3, s3, s57
    v_lshrrev_b32 v8, 3, v1
    v_lshlrev_b32 v5, 4, v8
    s_lshl_b32 s57, s60, 7
    v_add_u32 v5, s57, v5
    s_sub_u32 s57, s54, 4
    s_lshl_b32 s58, s57, 14
    v_add_u32 v6, s58, v4
    s_lshl_b32 s57, s57, 10
    v_add_u32 v4, s57, v4
    v_lshl_add_u32 v5, v5, 1, s57
    v_and_b32 v7, 7, v1
    v_lshlrev_b32 v7, 5, v7
    v_lshl_add_u32 v40, v8, 2, v7
    v_add_u32 v7, s3, v40
    v_and_b32 v8, 3, v8
    v_lshlrev_b32 v8, 3, v8
    s_mov_b32 s60, 0x05040100
    s_mov_b32 s61, 0x07060302
    s_waitcnt vmcnt(0)
    v_lshlrev_b32 v24, 16, v16
    v_and_b32 v25, 0xffff0000, v16
    v_lshlrev_b32 v26, 16, v17
    v_and_b32 v27, 0xffff0000, v17
    v_lshlrev_b32 v28, 16, v18
    v_and_b32 v29, 0xffff0000, v18
    v_lshlrev_b32 v30, 16, v19
    v_and_b32 v31, 0xffff0000, v19
    v_add_f32 v9, v24, v25
    v_add_f32 v9, v9, v26
    v_add_f32 v9, v9, v27
    v_add_f32 v9, v9, v28
    v_add_f32 v9, v9, v29
    v_add_f32 v9, v9, v30
    v_add_f32 v9, v9, v31
    s_nop 1
    v_add_f32_dpp v9, v9, v9 row_ror:8 row_mask:0xf bank_mask:0xf
    s_nop 1
    v_add_f32_dpp v9, v9, v9 row_ror:4 row_mask:0xf bank_mask:0xf
    s_nop 1
    v_add_f32_dpp v9, v9, v9 row_ror:2 row_mask:0xf bank_mask:0xf
    s_nop 1
    v_add_f32_dpp v9, v9, v9 row_ror:1 row_mask:0xf bank_mask:0xf
    v_mov_b32 v11, v9
    s_nop 1
    v_permlane16_swap_b32 v9, v11
    v_add_f32 v9, v9, v11
    v_mov_b32 v11, v9
    s_nop 1
    v_permlane32_swap_b32 v9, v11
    v_add_f32 v9, v9, v11
    v_mul_f32 v9, 0x3b000000, v9
    v_sub_f32 v32, v24, v9
    v_sub_f32 v33, v25, v9
    v_sub_f32 v34, v26, v9
    v_sub_f32 v35, v27, v9
    v_sub_f32 v36, v28, v9
    v_sub_f32 v37, v29, v9
    v_sub_f32 v38, v30, v9
    v_sub_f32 v39, v31, v9
    v_mul_f32 v10, v32, v32
    v_fmac_f32 v10, v33, v33
    v_fmac_f32 v10, v34, v34
    v_fmac_f32 v10, v35, v35
    v_fmac_f32 v10, v36, v36
    v_fmac_f32 v10, v37, v37
    v_fmac_f32 v10, v38, v38
    v_fmac_f32 v10, v39, v39
    s_nop 1
    v_add_f32_dpp v10, v10, v10 row_ror:8 row_mask:0xf bank_mask:0xf
    s_nop 1
    v_add_f32_dpp v10, v10, v10 row_ror:4 row_mask:0xf bank_mask:0xf
    s_nop 1
    v_add_f32_dpp v10, v10, v10 row_ror:2 row_mask:0xf bank_mask:0xf
    s_nop 1
    v_add_f32_dpp v10, v10, v10 row_ror:1 row_mask:0xf bank_mask:0xf
    v_mov_b32 v11, v10
    s_nop 1
    v_permlane16_swap_b32 v10, v11
    v_add_f32 v10, v10, v11
    v_mov_b32 v11, v10
    s_nop 1
    v_permlane32_swap_b32 v10, v11
    v_add_f32 v10, v10, v11
    v_mul_f32 v10, 0x3b000000, v10
    v_cvt_pk_bf16_f32 v9, v9, v9
    v_and_b32 v9, 0xffff0000, v9
    v_cvt_pk_bf16_f32 v10, v10, v10
    v_and_b32 v10, 0xffff0000, v10
    v_add_f32 v10, 0x3727c5ac, v10
    v_cvt_pk_bf16_f32 v10, v10, v10
    v_and_b32 v10, 0xffff0000, v10
    v_sqrt_f32 v10, v10
    v_sub_f32 v24, v24, v9
    v_sub_f32 v25, v25, v9
    v_sub_f32 v26, v26, v9
    v_sub_f32 v27, v27, v9
    v_sub_f32 v28, v28, v9
    v_sub_f32 v29, v29, v9
    v_sub_f32 v30, v30, v9
    v_sub_f32 v31, v31, v9
    v_cvt_pk_bf16_f32 v10, v10, v10
    v_and_b32 v10, 0xffff0000, v10
    v_rcp_f32 v10, v10
    v_cvt_pk_bf16_f32 v16, v24, v25
    v_cvt_pk_bf16_f32 v17, v26, v27
    v_cvt_pk_bf16_f32 v18, v28, v29
    v_cvt_pk_bf16_f32 v19, v30, v31
    v_lshlrev_b32 v24, 16, v16
    v_and_b32 v25, 0xffff0000, v16
    v_lshlrev_b32 v26, 16, v17
    v_and_b32 v27, 0xffff0000, v17
    v_lshlrev_b32 v28, 16, v18
    v_and_b32 v29, 0xffff0000, v18
    v_lshlrev_b32 v30, 16, v19
    v_and_b32 v31, 0xffff0000, v19
    v_mul_f32 v24, v24, v10
    v_mul_f32 v25, v25, v10
    v_mul_f32 v26, v26, v10
    v_mul_f32 v27, v27, v10
    v_mul_f32 v28, v28, v10
    v_mul_f32 v29, v29, v10
    v_mul_f32 v30, v30, v10
    v_mul_f32 v31, v31, v10
    v_cvt_pk_bf16_f32 v16, v24, v25
    v_cvt_pk_bf16_f32 v17, v26, v27
    v_cvt_pk_bf16_f32 v18, v28, v29
    v_cvt_pk_bf16_f32 v19, v30, v31
    ds_write_b128 v4, v[16:19] offset:1024
    s_waitcnt lgkmcnt(0)
    ds_read_b128 v[16:19], v5 offset:1024
    ds_read_b128 v[20:23], v5 offset:1040
    s_and_b32 s57, s55, 0x7f7f7f7f
    s_add_u32 s57, s57, 0x47611b35
    s_and_b32 s55, s55, 0x80808080
    s_xor_b32 s55, s55, s57
    v_lshrrev_b32 v41, v8, s55
    s_mov_b32 s64, 0x07060500
    s_waitcnt lgkmcnt(0)
    s_barrier
    s_cmp_eq_u32 s54, 4
    s_cbranch_scc1 L_tile2
    s_barrier
L_tile2:
    ds_read_b128 v[112:115], v6 offset:5376
    ds_read_b128 v[116:119], v6 offset:6400
    ds_read_b128 v[120:123], v6 offset:7424
    ds_read_b128 v[124:127], v6 offset:8448
    ds_read_b128 v[128:131], v6 offset:9472
    ds_read_b128 v[132:135], v6 offset:10496
    ds_read_b128 v[136:139], v6 offset:11520
    ds_read_b128 v[140:143], v6 offset:12544
    ds_read_b128 v[144:147], v6 offset:13568
    ds_read_b128 v[148:151], v6 offset:14592
    ds_read_b128 v[152:155], v6 offset:15616
    ds_read_b128 v[156:159], v6 offset:16640
    ds_read_b128 v[160:163], v6 offset:17664
    ds_read_b128 v[164:167], v6 offset:18688
    ds_read_b128 v[168:171], v6 offset:19712
    ds_read_b128 v[172:175], v6 offset:20736
    s_waitcnt lgkmcnt(14)
    v_perm_b32 v32, v116, v112, s60
    v_perm_b32 v33, v116, v112, s61
    v_perm_b32 v34, v117, v113, s60
    v_perm_b32 v35, v117, v113, s61
    v_perm_b32 v36, v118, v114, s60
    v_perm_b32 v37, v118, v114, s61
    v_perm_b32 v38, v119, v115, s60
    v_perm_b32 v39, v119, v115, s61
    v_dot2_f32_bf16 v24, v32, v16, 0
    v_dot2_f32_bf16 v25, v33, v16, 0
    v_dot2_f32_bf16 v26, v34, v16, 0
    v_dot2_f32_bf16 v27, v35, v16, 0
    v_dot2_f32_bf16 v28, v36, v16, 0
    v_dot2_f32_bf16 v29, v37, v16, 0
    v_dot2_f32_bf16 v30, v38, v16, 0
    v_dot2_f32_bf16 v31, v39, v16, 0
    s_waitcnt lgkmcnt(12)
    v_perm_b32 v32, v124, v120, s60
    v_perm_b32 v33, v124, v120, s61
    v_perm_b32 v34, v125, v121, s60
    v_perm_b32 v35, v125, v121, s61
    v_perm_b32 v36, v126, v122, s60
    v_perm_b32 v37, v126, v122, s61
    v_perm_b32 v38, v127, v123, s60
    v_perm_b32 v39, v127, v123, s61
    v_dot2_f32_bf16 v24, v32, v17, v24
    v_dot2_f32_bf16 v25, v33, v17, v25
    v_dot2_f32_bf16 v26, v34, v17, v26
    v_dot2_f32_bf16 v27, v35, v17, v27
    v_dot2_f32_bf16 v28, v36, v17, v28
    v_dot2_f32_bf16 v29, v37, v17, v29
    v_dot2_f32_bf16 v30, v38, v17, v30
    v_dot2_f32_bf16 v31, v39, v17, v31
    s_waitcnt lgkmcnt(10)
    v_perm_b32 v32, v132, v128, s60
    v_perm_b32 v33, v132, v128, s61
    v_perm_b32 v34, v133, v129, s60
    v_perm_b32 v35, v133, v129, s61
    v_perm_b32 v36, v134, v130, s60
    v_perm_b32 v37, v134, v130, s61
    v_perm_b32 v38, v135, v131, s60
    v_perm_b32 v39, v135, v131, s61
    v_dot2_f32_bf16 v24, v32, v18, v24
    v_dot2_f32_bf16 v25, v33, v18, v25
    v_dot2_f32_bf16 v26, v34, v18, v26
    v_dot2_f32_bf16 v27, v35, v18, v27
    v_dot2_f32_bf16 v28, v36, v18, v28
    v_dot2_f32_bf16 v29, v37, v18, v29
    v_dot2_f32_bf16 v30, v38, v18, v30
    v_dot2_f32_bf16 v31, v39, v18, v31
    s_waitcnt lgkmcnt(8)
    v_perm_b32 v32, v140, v136, s60
    v_perm_b32 v33, v140, v136, s61
    v_perm_b32 v34, v141, v137, s60
    v_perm_b32 v35, v141, v137, s61
    v_perm_b32 v36, v142, v138, s60
    v_perm_b32 v37, v142, v138, s61
    v_perm_b32 v38, v143, v139, s60
    v_perm_b32 v39, v143, v139, s61
    v_dot2_f32_bf16 v24, v32, v19, v24
    v_dot2_f32_bf16 v25, v33, v19, v25
    v_dot2_f32_bf16 v26, v34, v19, v26
    v_dot2_f32_bf16 v27, v35, v19, v27
    v_dot2_f32_bf16 v28, v36, v19, v28
    v_dot2_f32_bf16 v29, v37, v19, v29
    v_dot2_f32_bf16 v30, v38, v19, v30
    v_dot2_f32_bf16 v31, v39, v19, v31
    s_waitcnt lgkmcnt(6)
    v_perm_b32 v32, v148, v144, s60
    v_perm_b32 v33, v148, v144, s61
    v_perm_b32 v34, v149, v145, s60
    v_perm_b32 v35, v149, v145, s61
    v_perm_b32 v36, v150, v146, s60
    v_perm_b32 v37, v150, v146, s61
    v_perm_b32 v38, v151, v147, s60
    v_perm_b32 v39, v151, v147, s61
    v_dot2_f32_bf16 v24, v32, v20, v24
    v_dot2_f32_bf16 v25, v33, v20, v25
    v_dot2_f32_bf16 v26, v34, v20, v26
    v_dot2_f32_bf16 v27, v35, v20, v27
    v_dot2_f32_bf16 v28, v36, v20, v28
    v_dot2_f32_bf16 v29, v37, v20, v29
    v_dot2_f32_bf16 v30, v38, v20, v30
    v_dot2_f32_bf16 v31, v39, v20, v31
    s_waitcnt lgkmcnt(4)
    v_perm_b32 v32, v156, v152, s60
    v_perm_b32 v33, v156, v152, s61
    v_perm_b32 v34, v157, v153, s60
    v_perm_b32 v35, v157, v153, s61
    v_perm_b32 v36, v158, v154, s60
    v_perm_b32 v37, v158, v154, s61
    v_perm_b32 v38, v159, v155, s60
    v_perm_b32 v39, v159, v155, s61
    v_dot2_f32_bf16 v24, v32, v21, v24
    v_dot2_f32_bf16 v25, v33, v21, v25
    v_dot2_f32_bf16 v26, v34, v21, v26
    v_dot2_f32_bf16 v27, v35, v21, v27
    v_dot2_f32_bf16 v28, v36, v21, v28
    v_dot2_f32_bf16 v29, v37, v21, v29
    v_dot2_f32_bf16 v30, v38, v21, v30
    v_dot2_f32_bf16 v31, v39, v21, v31
    s_waitcnt lgkmcnt(2)
    v_perm_b32 v32, v164, v160, s60
    v_perm_b32 v33, v164, v160, s61
    v_perm_b32 v34, v165, v161, s60
    v_perm_b32 v35, v165, v161, s61
    v_perm_b32 v36, v166, v162, s60
    v_perm_b32 v37, v166, v162, s61
    v_perm_b32 v38, v167, v163, s60
    v_perm_b32 v39, v167, v163, s61
    v_dot2_f32_bf16 v24, v32, v22, v24
    v_dot2_f32_bf16 v25, v33, v22, v25
    v_dot2_f32_bf16 v26, v34, v22, v26
    v_dot2_f32_bf16 v27, v35, v22, v27
    v_dot2_f32_bf16 v28, v36, v22, v28
    v_dot2_f32_bf16 v29, v37, v22, v29
    v_dot2_f32_bf16 v30, v38, v22, v30
    v_dot2_f32_bf16 v31, v39, v22, v31
    s_waitcnt lgkmcnt(0)
    v_perm_b32 v32, v172, v168, s60
    v_perm_b32 v33, v172, v168, s61
    v_perm_b32 v34, v173, v169, s60
    v_perm_b32 v35, v173, v169, s61
    v_perm_b32 v36, v174, v170, s60
    v_perm_b32 v37, v174, v170, s61
    v_perm_b32 v38, v175, v171, s60
    v_perm_b32 v39, v175, v171, s61
    v_dot2_f32_bf16 v24, v32, v23, v24
    v_dot2_f32_bf16 v25, v33, v23, v25
    v_dot2_f32_bf16 v26, v34, v23, v26
    v_dot2_f32_bf16 v27, v35, v23, v27
    v_dot2_f32_bf16 v28, v36, v23, v28
    v_dot2_f32_bf16 v29, v37, v23, v29
    v_dot2_f32_bf16 v30, v38, v23, v30
    v_dot2_f32_bf16 v31, v39, v23, v31
    s_nop 2
    v_permlane32_swap_b32 v24, v28
    v_permlane32_swap_b32 v25, v29
    v_permlane32_swap_b32 v26, v30
    v_permlane32_swap_b32 v27, v31
    v_add_f32 v24, v24, v28
    v_add_f32 v25, v25, v29
    v_add_f32 v26, v26, v30
    v_add_f32 v27, v27, v31
    s_nop 0
    v_permlane16_swap_b32 v24, v26
    v_permlane16_swap_b32 v25, v27
    v_add_f32 v24, v24, v26
    v_add_f32 v25, v25, v27
    s_nop 0
    v_add_f32_dpp v28, v24, v24 row_ror:8 row_mask:0xf bank_mask:0x3
    s_nop 1
    v_add_f32_dpp v28, v25, v25 row_ror:8 row_mask:0xf bank_mask:0xc
    v_perm_b32 v28, v28, v41, s64
    s_cmp_eq_u32 s54, 4
    s_cbranch_scc0 L_h1
    s_getreg_b32 s11, hwreg(HW_REG_XCC_ID, 0, 4)
    s_and_b32 s57, s55, 0xfffffff0
    s_or_b32 s11, s11, s57
    v_mov_b32 v30, s11
    v_mov_b32 v29, v7
    s_lshl_b32 s57, s52, 12
    s_add_u32 s57, s57, 0x28000
    v_and_b32 v32, 31, v1
    s_lshl_b32 s58, s53, 7
    s_add_u32 s58, s58, s57
    v_lshl_add_u32 v31, v32, 2, s58
    v_lshl_add_u32 v32, v32, 7, s57
    buffer_store_dword v28, v29, s[48:51], 0 offen
    buffer_store_dword v30, v31, s[48:51], 0 offen
    s_mov_b32 s65, 0x0c0c0400
    s_mov_b32 s66, 0x04000c0c
    v_mov_b32 v2, s55
    s_lshl_b32 s57, s52, 13
    s_add_u32 s57, s57, 0x0
    v_lshrrev_b32 v4, 5, v1
    v_and_b32 v5, 31, v1
    v_lshlrev_b32 v6, 11, v4
    v_lshlrev_b32 v7, 4, v5
    v_add3_u32 v6, v6, v7, s57
    s_movk_i32 s59, 0x1000
    v_lshrrev_b32 v5, 1, v5
    v_lshlrev_b32 v5, 6, v5
    v_and_b32 v7, 1, v1
    v_lshlrev_b32 v7, 3, v7
    v_lshl_add_u32 v5, v4, 2, v5
    v_add_u32 v5, v5, v7
    s_mov_b32 s9, 4
    s_barrier
    s_mov_b32 s63, 200000
L_again_99:
    s_sub_u32 s9, s9, 1
    s_cmp_lg_u32 s9, 0
    s_cbranch_scc1 L_qtry
    buffer_store_dword v28, v29, s[48:51], 0 offen sc1
    buffer_store_dword v30, v31, s[48:51], 0 offen sc1
L_qtry:
    buffer_load_dwordx4 v[112:115], v6, s[48:51], 0 offen offset:0 sc1
    buffer_load_dwordx4 v[116:119], v6, s[48:51], s59 offen offset:0 sc1
    buffer_load_dwordx4 v[120:123], v6, s[48:51], 0 offen offset:512 sc1
    buffer_load_dwordx4 v[124:127], v6, s[48:51], s59 offen offset:512 sc1
    buffer_load_dwordx4 v[128:131], v6, s[48:51], 0 offen offset:1024 sc1
    buffer_load_dwordx4 v[132:135], v6, s[48:51], s59 offen offset:1024 sc1
    buffer_load_dwordx4 v[136:139], v6, s[48:51], 0 offen offset:1536 sc1
    buffer_load_dwordx4 v[140:143], v6, s[48:51], s59 offen offset:1536 sc1
    buffer_load_dword v33, v32, s[48:51], 0 offen sc1
    s_sub_u32 s63, s63, 1
    s_waitcnt vmcnt(0)
    s_cbranch_scc1 L_done_100
    v_perm_b32 v8, v113, v112, s65
    v_perm_b32 v9, v115, v114, s66
    v_bitop3_b32 v10, v8, v9, v2 bitop3:0x56
    v_perm_b32 v8, v117, v116, s65
    v_perm_b32 v9, v119, v118, s66
    v_bitop3_b32 v8, v8, v9, v2 bitop3:0x56
    v_or_b32 v10, v10, v8
    v_perm_b32 v8, v121, v120, s65
    v_perm_b32 v9, v123, v122, s66
    v_bitop3_b32 v8, v8, v9, v2 bitop3:0x56
    v_or_b32 v10, v10, v8
    v_perm_b32 v8, v125, v124, s65
    v_perm_b32 v9, v127, v126, s66
    v_bitop3_b32 v8, v8, v9, v2 bitop3:0x56
    v_or_b32 v10, v10, v8
    v_perm_b32 v8, v129, v128, s65
    v_perm_b32 v9, v131, v130, s66
    v_bitop3_b32 v8, v8, v9, v2 bitop3:0x56
    v_or_b32 v10, v10, v8
    v_perm_b32 v8, v133, v132, s65
    v_perm_b32 v9, v135, v134, s66
    v_bitop3_b32 v8, v8, v9, v2 bitop3:0x56
    v_or_b32 v10, v10, v8
    v_perm_b32 v8, v137, v136, s65
    v_perm_b32 v9, v139, v138, s66
    v_bitop3_b32 v8, v8, v9, v2 bitop3:0x56
    v_or_b32 v10, v10, v8
    v_perm_b32 v8, v141, v140, s65
    v_perm_b32 v9, v143, v142, s66
    v_bitop3_b32 v8, v8, v9, v2 bitop3:0x56
    v_or_b32 v10, v10, v8
    v_xor_b32 v8, s55, v33
    v_lshrrev_b32 v8, 4, v8
    v_or_b32 v10, v10, v8
    v_cmp_ne_u32 vcc, 0, v10
    s_cbranch_vccnz L_again_99
L_done_100:
    v_cmp_ne_u32 vcc, s11, v33
    v_mov_b32 v9, 5244
    s_cmp_eq_u64 vcc, 0
    s_cselect_b32 s10, 1, 0
    s_cbranch_scc1 L_qnear
    buffer_store_dword v28, v29, s[48:51], 0 offen sc1
    buffer_store_dword v30, v31, s[48:51], 0 offen sc1
L_qnear:
    v_mov_b32 v8, s10
    ds_write_b32 v9, v8
    v_and_b32 v112, 0xffffff00, v112
    v_and_b32 v113, 0xffffff00, v113
    v_and_b32 v114, 0xffffff00, v114
    v_and_b32 v115, 0xffffff00, v115
    v_and_b32 v116, 0xffffff00, v116
    v_and_b32 v117, 0xffffff00, v117
    v_and_b32 v118, 0xffffff00, v118
    v_and_b32 v119, 0xffffff00, v119
    v_and_b32 v120, 0xffffff00, v120
    v_and_b32 v121, 0xffffff00, v121
    v_and_b32 v122, 0xffffff00, v122
    v_and_b32 v123, 0xffffff00, v123
    v_and_b32 v124, 0xffffff00, v124
    v_and_b32 v125, 0xffffff00, v125
    v_and_b32 v126, 0xffffff00, v126
    v_and_b32 v127, 0xffffff00, v127
    v_and_b32 v128, 0xffffff00, v128
    v_and_b32 v129, 0xffffff00, v129
    v_and_b32 v130, 0xffffff00, v130
    v_and_b32 v131, 0xffffff00, v131
    v_and_b32 v132, 0xffffff00, v132
    v_and_b32 v133, 0xffffff00, v133
    v_and_b32 v134, 0xffffff00, v134
    v_and_b32 v135, 0xffffff00, v135
    v_and_b32 v136, 0xffffff00, v136
    v_and_b32 v137, 0xffffff00, v137
    v_and_b32 v138, 0xffffff00, v138
    v_and_b32 v139, 0xffffff00, v139
    v_and_b32 v140, 0xffffff00, v140
    v_and_b32 v141, 0xffffff00, v141
    v_and_b32 v142, 0xffffff00, v142
    v_and_b32 v143, 0xffffff00, v143
    v_add_f32 v112, v112, v116
    v_add_f32 v113, v113, v117
    v_add_f32 v114, v114, v118
    v_add_f32 v115, v115, v119
    v_add_f32 v120, v120, v124
    v_add_f32 v121, v121, v125
    v_add_f32 v122, v122, v126
    v_add_f32 v123, v123, v127
    v_add_f32 v128, v128, v132
    v_add_f32 v129, v129, v133
    v_add_f32 v130, v130, v134
    v_add_f32 v131, v131, v135
    v_add_f32 v136, v136, v140
    v_add_f32 v137, v137, v141
    v_add_f32 v138, v138, v142
    v_add_f32 v139, v139, v143
    v_permlane32_swap_b32 v112, v114
    v_permlane32_swap_b32 v113, v115
    v_permlane32_swap_b32 v120, v122
    v_permlane32_swap_b32 v121, v123
    v_permlane32_swap_b32 v128, v130
    v_permlane32_swap_b32 v129, v131
    v_permlane32_swap_b32 v136, v138
    v_permlane32_swap_b32 v137, v139
    v_add_f32 v112, v112, v114
    v_add_f32 v113, v113, v115
    v_cvt_pk_bf16_f32 v112, v112, v113
    ds_write_b32 v5, v112 offset:0
    v_add_f32 v120, v120, v122
    v_add_f32 v121, v121, v123
    v_cvt_pk_bf16_f32 v120, v120, v121
    ds_write_b32 v5, v120 offset:16
    v_add_f32 v128, v128, v130
    v_add_f32 v129, v129, v131
    v_cvt_pk_bf16_f32 v128, v128, v129
    ds_write_b32 v5, v128 offset:32
    v_add_f32 v136, v136, v138
    v_add_f32 v137, v137, v139
    v_cvt_pk_bf16_f32 v136, v136, v137
    ds_write_b32 v5, v136 offset:48
    s_waitcnt lgkmcnt(0)
    s_barrier
    v_and_b32 v4, 3, v1
    v_lshlrev_b32 v4, 4, v4
    s_lshl_b32 s59, s52, 11
    s_add_u32 s59, s59, 0x20000
    s_lshl_b32 s58, s53, 4
    s_add_u32 s57, s59, s58
    v_lshl_add_u32 v5, v4, 5, s57
    s_lshr_b32 s58, s53, 3
    s_lshl_b32 s58, s58, 9
    s_add_u32 s57, s59, s58
    v_and_b32 v6, 31, v1
    v_lshlrev_b32 v7, 2, v6
    v_lshl_add_u32 v6, v6, 4, s57
    v_mov_b32 v18, s55
    v_mov_b32 v19, s55
    s_mov_b32 s62, 0x3fb8aa3b
    s_barrier
    ds_read_b128 v[24:27], v4 offset:3072
    s_waitcnt lgkmcnt(0)
    v_max3_f32 v16, v24, v25, v26
    v_max_f32 v16, v16, v27
    s_barrier
    ds_read_b128 v[24:27], v4 offset:3200
    s_waitcnt lgkmcnt(0)
    v_add_f32 v24, v24, v26
    v_add_f32 v25, v25, v27
    v_add_f32 v17, v24, v25
    s_mov_b64 exec, 0xf
    s_cmp_eq_u32 s10, 1
    s_cbranch_scc1 L_mlnear
    buffer_store_dwordx4 v[16:19], v5, s[48:51], 0 offen sc1
    s_branch L_mlfar
L_mlnear:
    buffer_store_dwordx4 v[16:19], v5, s[48:51], 0 offen
L_mlfar:
    s_mov_b64 exec, -1
    s_barrier
    s_mov_b32 s63, 200000
L_again_101:
    buffer_load_dwordx4 v[32:35], v6, s[48:51], 0 offen sc1
    s_sub_u32 s63, s63, 1
    s_waitcnt vmcnt(0)
    s_cbranch_scc1 L_done_102
    v_xor_b32 v8, s55, v34
    v_xor_b32 v9, s55, v35
    v_or_b32 v8, v8, v9
    v_cmp_ne_u32 vcc, 0, v8
    s_cbranch_vccnz L_again_101
L_done_102:
    v_mov_b32 v8, v32
    s_nop 1
    v_max_f32_dpp v8, v8, v8 row_ror:8 row_mask:0xf bank_mask:0xf
    s_nop 1
    v_max_f32_dpp v8, v8, v8 row_ror:4 row_mask:0xf bank_mask:0xf
    s_nop 1
    v_max_f32_dpp v8, v8, v8 row_ror:2 row_mask:0xf bank_mask:0xf
    s_nop 1
    v_max_f32_dpp v8, v8, v8 row_ror:1 row_mask:0xf bank_mask:0xf
    v_mov_b32 v10, v8
    s_nop 1
    v_permlane16_swap_b32 v8, v10
    v_max_f32 v8, v8, v10
    v_sub_f32 v8, v32, v8
    v_mul_f32 v8, s62, v8
    v_exp_f32 v8, v8
    s_nop 0
    v_mul_f32 v9, v8, v33
    s_nop 1
    v_add_f32_dpp v9, v9, v9 row_ror:8 row_mask:0xf bank_mask:0xf
    s_nop 1
    v_add_f32_dpp v9, v9, v9 row_ror:4 row_mask:0xf bank_mask:0xf
    s_nop 1
    v_add_f32_dpp v9, v9, v9 row_ror:2 row_mask:0xf bank_mask:0xf
    s_nop 1
    v_add_f32_dpp v9, v9, v9 row_ror:1 row_mask:0xf bank_mask:0xf
    v_mov_b32 v10, v9
    s_nop 1
    v_permlane16_swap_b32 v9, v10
    v_add_f32 v9, v9, v10
    v_rcp_f32 v9, v9
    s_nop 0
    v_mul_f32 v8, v8, v9
    ds_write_b32 v7, v8 offset:3312
    s_waitcnt lgkmcnt(0)
    s_branch L_Z
L_h1:
    buffer_store_dword v28, v7, s[48:51], 0 offen sc1
    s_mov_b64 s[32:33], s[20:21]
    s_mov_b32 s34, 0x1c0000
    s_mov_b32 s35, 0x20000
    s_mul_i32 s8, s52, 28
    s_add_u32 s8, s8, s53
    s_lshr_b32 s9, s8, 3
    s_and_b32 s10, s8, 7
    s_lshl_b32 s57, s9, 16
    s_lshl_b32 s58, s10, 7
    s_add_u32 s57, s57, s58
    v_lshrrev_b32 v6, 3, v1
    v_lshlrev_b32 v4, 13, v6
    v_lshlrev_b32 v6, 4, v6
    v_and_b32 v5, 7, v1
    v_lshlrev_b32 v5, 4, v5
    v_add3_u32 v4, v4, v5, s57
    s_movk_i32 s59, 0x1000
    buffer_load_dwordx4 v[112:115], v4, s[32:35], 0 offen offset:0 nt
    buffer_load_dwordx4 v[116:119], v4, s[32:35], 0 offen offset:1024 nt
    buffer_load_dwordx4 v[120:123], v4, s[32:35], 0 offen offset:2048 nt
    buffer_load_dwordx4 v[124:127], v4, s[32:35], 0 offen offset:3072 nt
    buffer_load_dwordx4 v[128:131], v4, s[32:35], s59 offen offset:0 nt
    buffer_load_dwordx4 v[132:135], v4, s[32:35], s59 offen offset:1024 nt
    buffer_load_dwordx4 v[136:139], v4, s[32:35], s59 offen offset:2048 nt
    buffer_load_dwordx4 v[140:143], v4, s[32:35], s59 offen offset:3072 nt
    s_lshl_b32 s57, s9, 8
    s_add_u32 s57, s57, 0x10000
    v_lshl_add_u32 v5, v1, 2, s57
    v_and_b32 v7, 3, v1
    v_lshlrev_b32 v7, 3, v7
    v_lshrrev_b32 v3, v7, s55
    v_lshlrev_b32 v7, 1, v1
    s_lshl_b32 s57, s10, 13
    s_lshl_b32 s58, s9, 8
    s_add_u32 s57, s57, s58
    s_add_u32 s57, s57, 0x30000
    v_add_u32 v40, s57, v40
    s_barrier
    s_barrier
    s_barrier
    s_mov_b32 s63, 200000
L_again_103:
    buffer_load_dword v32, v5, s[48:51], 0 offen sc1
    s_movk_i32 s59, 7168
    buffer_load_dword v33, v5, s[48:51], s59 offen sc1
    s_movk_i32 s59, 14336
    buffer_load_dword v34, v5, s[48:51], s59 offen sc1
    s_movk_i32 s59, 21504
    buffer_load_dword v35, v5, s[48:51], s59 offen sc1
    s_movk_i32 s59, 0
    v_add_u32 v8, 0x7000, v5
    buffer_load_dword v36, v8, s[48:51], s59 offen sc1
    s_movk_i32 s59, 7168
    buffer_load_dword v37, v8, s[48:51], s59 offen sc1
    s_movk_i32 s59, 14336
    buffer_load_dword v38, v8, s[48:51], s59 offen sc1
    s_movk_i32 s59, 21504
    buffer_load_dword v39, v8, s[48:51], s59 offen sc1
    s_sub_u32 s63, s63, 1
    s_waitcnt vmcnt(0)
    s_cbranch_scc1 L_done_104
    v_xor_b32 v8, v32, v3
    v_bitop3_b32 v8, v33, v3, v8 bitop3:0xbe
    v_bitop3_b32 v8, v34, v3, v8 bitop3:0xbe
    v_bitop3_b32 v8, v35, v3, v8 bitop3:0xbe
    v_bitop3_b32 v8, v36, v3, v8 bitop3:0xbe
    v_bitop3_b32 v8, v37, v3, v8 bitop3:0xbe
    v_bitop3_b32 v8, v38, v3, v8 bitop3:0xbe
    v_bitop3_b32 v8, v39, v3, v8 bitop3:0xbe
    v_and_b32 v8, 0xff, v8
    v_cmp_ne_u32 vcc, 0, v8
    s_cbranch_vccnz L_again_103
L_done_104:
    v_and_b32 v32, 0xffffff00, v32
    v_and_b32 v33, 0xffffff00, v33
    v_and_b32 v34, 0xffffff00, v34
    v_and_b32 v35, 0xffffff00, v35
    v_and_b32 v36, 0xffffff00, v36
    v_and_b32 v37, 0xffffff00, v37
    v_and_b32 v38, 0xffffff00, v38
    v_and_b32 v39, 0xffffff00, v39
    v_add_f32 v32, v32, v33
    v_add_f32 v34, v34, v35
    v_add_f32 v32, v32, v34
    v_cvt_pk_bf16_f32 v32, v32, v32
    v_and_b32 v32, 0xffff0000, v32
    v_add_f32 v36, v36, v37
    v_add_f32 v38, v38, v39
    v_add_f32 v36, v36, v38
    v_cvt_pk_bf16_f32 v36, v36, v36
    v_and_b32 v36, 0xffff0000, v36
    v_mul_f32 v34, 0x3fb8aa3b, v32
    v_exp_f32 v34, -v34
    s_nop 0
    v_add_f32 v34, 1.0, v34
    v_rcp_f32 v34, v34
    s_nop 0
    v_mul_f32 v34, v32, v34
    v_cvt_pk_bf16_f32 v33, v34, v34
    v_and_b32 v33, 0xffff0000, v33
    v_mul_f32 v33, v33, v36
    v_cvt_pk_bf16_f32 v33, v33, v33
    ds_write_b16 v7, v33 offset:5248
    s_waitcnt lgkmcnt(0)
    ds_read_b128 v[16:19], v6 offset:5248
    s_waitcnt lgkmcnt(0)
    v_perm_b32 v32, v116, v112, s60
    v_perm_b32 v33, v116, v112, s61
    v_perm_b32 v34, v117, v113, s60
    v_perm_b32 v35, v117, v113, s61
    v_perm_b32 v36, v118, v114, s60
    v_perm_b32 v37, v118, v114, s61
    v_perm_b32 v38, v119, v115, s60
    v_perm_b32 v39, v119, v115, s61
    v_dot2_f32_bf16 v24, v32, v16, 0
    v_dot2_f32_bf16 v25, v33, v16, 0
    v_dot2_f32_bf16 v26, v34, v16, 0
    v_dot2_f32_bf16 v27, v35, v16, 0
    v_dot2_f32_bf16 v28, v36, v16, 0
    v_dot2_f32_bf16 v29, v37, v16, 0
    v_dot2_f32_bf16 v30, v38, v16, 0
    v_dot2_f32_bf16 v31, v39, v16, 0
    v_perm_b32 v32, v124, v120, s60
    v_perm_b32 v33, v124, v120, s61
    v_perm_b32 v34, v125, v121, s60
    v_perm_b32 v35, v125, v121, s61
    v_perm_b32 v36, v126, v122, s60
    v_perm_b32 v37, v126, v122, s61
    v_perm_b32 v38, v127, v123, s60
    v_perm_b32 v39, v127, v123, s61
    v_dot2_f32_bf16 v24, v32, v17, v24
    v_dot2_f32_bf16 v25, v33, v17, v25
    v_dot2_f32_bf16 v26, v34, v17, v26
    v_dot2_f32_bf16 v27, v35, v17, v27
    v_dot2_f32_bf16 v28, v36, v17, v28
    v_dot2_f32_bf16 v29, v37, v17, v29
    v_dot2_f32_bf16 v30, v38, v17, v30
    v_dot2_f32_bf16 v31, v39, v17, v31
    v_perm_b32 v32, v132, v128, s60
    v_perm_b32 v33, v132, v128, s61
    v_perm_b32 v34, v133, v129, s60
    v_perm_b32 v35, v133, v129, s61
    v_perm_b32 v36, v134, v130, s60
    v_perm_b32 v37, v134, v130, s61
    v_perm_b32 v38, v135, v131, s60
    v_perm_b32 v39, v135, v131, s61
    v_dot2_f32_bf16 v24, v32, v18, v24
    v_dot2_f32_bf16 v25, v33, v18, v25
    v_dot2_f32_bf16 v26, v34, v18, v26
    v_dot2_f32_bf16 v27, v35, v18, v27
    v_dot2_f32_bf16 v28, v36, v18, v28
    v_dot2_f32_bf16 v29, v37, v18, v29
    v_dot2_f32_bf16 v30, v38, v18, v30
    v_dot2_f32_bf16 v31, v39, v18, v31
    v_perm_b32 v32, v140, v136, s60
    v_perm_b32 v33, v140, v136, s61
    v_perm_b32 v34, v141, v137, s60
    v_perm_b32 v35, v141, v137, s61
    v_perm_b32 v36, v142, v138, s60
    v_perm_b32 v37, v142, v138, s61
    v_perm_b32 v38, v143, v139, s60
    v_perm_b32 v39, v143, v139, s61
    v_dot2_f32_bf16 v24, v32, v19, v24
    v_dot2_f32_bf16 v25, v33, v19, v25
    v_dot2_f32_bf16 v26, v34, v19, v26
    v_dot2_f32_bf16 v27, v35, v19, v27
    v_dot2_f32_bf16 v28, v36, v19, v28
    v_dot2_f32_bf16 v29, v37, v19, v29
    v_dot2_f32_bf16 v30, v38, v19, v30
    v_dot2_f32_bf16 v31, v39, v19, v31
    s_nop 2
    v_permlane32_swap_b32 v24, v28
    v_permlane32_swap_b32 v25, v29
    v_permlane32_swap_b32 v26, v30
    v_permlane32_swap_b32 v27, v31
    v_add_f32 v24, v24, v28
    v_add_f32 v25, v25, v29
    v_add_f32 v26, v26, v30
    v_add_f32 v27, v27, v31
    s_nop 0
    v_permlane16_swap_b32 v24, v26
    v_permlane16_swap_b32 v25, v27
    v_add_f32 v24, v24, v26
    v_add_f32 v25, v25, v27
    s_nop 0
    v_add_f32_dpp v28, v24, v24 row_ror:8 row_mask:0xf bank_mask:0x3
    s_nop 1
    v_add_f32_dpp v28, v25, v25 row_ror:8 row_mask:0xf bank_mask:0xc
    v_perm_b32 v28, v28, v41, s64
    buffer_store_dword v28, v40, s[48:51], 0 offen sc1
    s_barrier
    s_branch L_Z
L_h23:
    s_waitcnt lgkmcnt(0)
    s_and_b32 s57, s55, 0x7f7f7f7f
    s_add_u32 s57, s57, 0x47611b35
    s_and_b32 s55, s55, 0x80808080
    s_xor_b32 s55, s55, s57
    s_cmp_eq_u32 s54, 7
    s_cbranch_scc1 L_h3
    s_barrier
    s_barrier
    s_barrier
    s_barrier
    s_barrier
    s_barrier
    s_cmp_lg_u32 s54, 6
    s_cbranch_scc1 L_Z
    s_cmp_ge_u32 s2, 16
    s_cbranch_scc1 L_Z
    v_mov_b32 v2, s55
    s_mov_b32 s65, 0x0c0c0400
    s_mov_b32 s66, 0x04000c0c
    s_lshr_b32 s57, s2, 1
    s_lshl_b32 s57, s57, 13
    s_and_b32 s58, s2, 1
    s_lshl_b32 s58, s58, 7
    s_add_u32 s57, s57, s58
    s_add_u32 s57, s57, 0x30000
    v_and_b32 v5, 7, v1
    v_lshlrev_b32 v6, 4, v5
    v_lshrrev_b32 v4, 3, v1
    v_lshlrev_b32 v4, 8, v4
    v_add3_u32 v4, v4, v6, s57
    v_lshrrev_b32 v6, 4, v1
    v_lshl_add_u32 v5, v5, 2, v6
    s_lshl_b32 s57, s2, 6
    v_lshl_add_u32 v6, v5, 1, s57
    v_lshlrev_b32 v5, 2, v5
    buffer_load_short_d16_hi v7, v6, s[36:39], 0 offen
    v_bfe_u32 v124, v2, 0, 8
    v_bfe_u32 v125, v2, 8, 8
    v_bfe_u32 v126, v2, 16, 8
    v_bfe_u32 v127, v2, 24, 8
    s_mov_b32 s63, 200000
L_again_105:
    buffer_load_dwordx4 v[112:115], v4, s[48:51], 0 offen offset:0 sc1
    buffer_load_dwordx4 v[116:119], v4, s[48:51], 0 offen offset:2048 sc1
    s_movk_i32 s59, 0x1000
    buffer_load_dwordx4 v[120:123], v4, s[48:51], s59 offen offset:0 sc1
    s_mov_b32 exec_lo, 0xffffffff
    s_mov_b32 exec_hi, 0x0
    s_movk_i32 s59, 0x1000
    buffer_load_dwordx4 v[124:127], v4, s[48:51], s59 offen offset:2048 sc1
    s_mov_b64 exec, -1
    s_sub_u32 s63, s63, 1
    s_waitcnt vmcnt(0)
    s_cbranch_scc1 L_done_106
    v_perm_b32 v8, v113, v112, s65
    v_perm_b32 v9, v115, v114, s66
    v_bitop3_b32 v10, v8, v9, v2 bitop3:0x56
    v_perm_b32 v8, v117, v116, s65
    v_perm_b32 v9, v119, v118, s66
    v_bitop3_b32 v8, v8, v9, v2 bitop3:0x56
    v_or_b32 v10, v10, v8
    v_perm_b32 v8, v121, v120, s65
    v_perm_b32 v9, v123, v122, s66
    v_bitop3_b32 v8, v8, v9, v2 bitop3:0x56
    v_or_b32 v10, v10, v8
    v_perm_b32 v8, v125, v124, s65
    v_perm_b32 v9, v127, v126, s66
    v_bitop3_b32 v8, v8, v9, v2 bitop3:0x56
    v_or_b32 v10, v10, v8
    v_cmp_ne_u32 vcc, 0, v10
    s_cbranch_vccnz L_again_105
L_done_106:
    v_and_b32 v112, 0xffffff00, v112
    v_and_b32 v113, 0xffffff00, v113
    v_and_b32 v114, 0xffffff00, v114
    v_and_b32 v115, 0xffffff00, v115
    v_and_b32 v116, 0xffffff00, v116
    v_and_b32 v117, 0xffffff00, v117
    v_and_b32 v118, 0xffffff00, v118
    v_and_b32 v119, 0xffffff00, v119
    v_and_b32 v120, 0xffffff00, v120
    v_and_b32 v121, 0xffffff00, v121
    v_and_b32 v122, 0xffffff00, v122
    v_and_b32 v123, 0xffffff00, v123
    v_and_b32 v124, 0xffffff00, v124
    v_and_b32 v125, 0xffffff00, v125
    v_and_b32 v126, 0xffffff00, v126
    v_and_b32 v127, 0xffffff00, v127
    v_add_f32 v112, v112, v116
    v_add_f32 v113, v113, v117
    v_add_f32 v114, v114, v118
    v_add_f32 v115, v115, v119
    v_add_f32 v112, v112, v120
    v_add_f32 v113, v113, v121
    v_add_f32 v114, v114, v122
    v_add_f32 v115, v115, v123
    v_add_f32 v112, v112, v124
    v_add_f32 v113, v113, v125
    v_add_f32 v114, v114, v126
    v_add_f32 v115, v115, v127
    s_nop 1
    v_permlane32_swap_b32 v112, v114
    v_permlane32_swap_b32 v113, v115
    v_add_f32 v112, v112, v114
    v_add_f32 v113, v113, v115
    s_nop 1
    v_permlane16_swap_b32 v112, v113
    v_add_f32 v112, v112, v113
    s_nop 1
    v_add_f32_dpp v112, v112, v112 row_ror:8 row_mask:0xf bank_mask:0xf
    v_cvt_pk_bf16_f32 v112, v112, v112
    v_and_b32 v112, 0xffff0000, v112
    v_mul_f32 v9, 0x3fb8aa3b, v112
    v_exp_f32 v9, -v9
    s_nop 0
    v_add_f32 v9, 1.0, v9
    v_rcp_f32 v9, v9
    s_nop 0
    v_mul_f32 v9, v112, v9
    v_cvt_pk_bf16_f32 v8, v9, v9
    v_and_b32 v8, 0xffff0000, v8
    ds_write_b32 v5, v8 offset:3440
    ds_write_b32 v5, v7 offset:3568
    v_mov_b32 v8, 5236
    v_mov_b32 v9, 0
    ds_write_b32 v8, v9
    s_branch L_Z
L_h3:
    v_mov_b32 v4, 5240
    v_mov_b32 v5, 0
    ds_write_b32 v4, v5
    s_lshl_b32 s58, s52, 7
    s_add_u32 s58, s58, 0x24000
    v_and_b32 v6, 31, v1
    v_lshl_add_u32 v6, v6, 2, s58
    s_lshl_b32 s57, s53, 2
    s_add_u32 s58, s58, s57
    v_mov_b32 v7, s58
    v_mov_b32 v8, s55
    s_waitcnt lgkmcnt(0)
    s_barrier
    s_barrier
    s_mov_b64 exec, 1
    buffer_store_dword v8, v7, s[48:51], 0 offen offset:0
    s_mov_b64 exec, -1
    buffer_load_dword v9, v6, s[48:51], 0 offen offset:0 sc1
    s_waitcnt vmcnt(0)
    v_cmp_eq_u32 vcc, v8, v9
    s_bcnt1_i32_b32 s57, vcc_lo
    s_cmp_gt_u32 s57, 26
    s_cselect_b32 s58, 1, 0
    v_mov_b32 v5, s58
    ds_write_b32 v4, v5
    s_barrier
    s_mov_b64 exec, 1
    buffer_store_dword v8, v7, s[48:51], 0 offen offset:1024
    s_mov_b64 exec, -1
    buffer_load_dword v9, v6, s[48:51], 0 offen offset:1024 sc1
    s_waitcnt vmcnt(0)
    v_cmp_eq_u32 vcc, v8, v9
    s_bcnt1_i32_b32 s57, vcc_lo
    s_cmp_gt_u32 s57, 26
    s_cselect_b32 s58, 1, 0
    v_mov_b32 v5, s58
    ds_write_b32 v4, v5
    s_barrier
    s_barrier
    s_mov_b64 exec, 1
    buffer_store_dword v8, v7, s[48:51], 0 offen offset:2048
    s_mov_b64 exec, -1
    buffer_load_dword v9, v6, s[48:51], 0 offen offset:2048 sc1
    s_waitcnt vmcnt(0)
    v_cmp_eq_u32 vcc, v8, v9
    s_bcnt1_i32_b32 s57, vcc_lo
    s_cmp_gt_u32 s57, 26
    s_cselect_b32 s58, 1, 0
    v_mov_b32 v5, s58
    ds_write_b32 v4, v5
    s_barrier
    s_mov_b64 exec, 1
    buffer_store_dword v8, v7, s[48:51], 0 offen offset:3072
    s_mov_b64 exec, -1
    buffer_load_dword v9, v6, s[48:51], 0 offen offset:3072 sc1
    s_waitcnt vmcnt(0)
    v_cmp_eq_u32 vcc, v8, v9
    s_bcnt1_i32_b32 s57, vcc_lo
    s_cmp_gt_u32 s57, 26
    s_cselect_b32 s58, 1, 0
    v_mov_b32 v5, s58
    ds_write_b32 v4, v5
    s_branch L_Z
L_exit0:
L_exit:
L_end:
    s_endpgm
.section .rodata,"a"
.p2align 6
.amdhsa_kernel recurrent_scan__gqa_block_cached__swiglu_ffn__decode_kernel
  .amdhsa_next_free_vgpr 256
  .amdhsa_next_free_sgpr 102
  .amdhsa_accum_offset 256
  .amdhsa_group_segment_fixed_size 0
  .amdhsa_kernarg_size 96
  .amdhsa_user_sgpr_count 2
  .amdhsa_user_sgpr_kernarg_segment_ptr 1
  .amdhsa_system_sgpr_workgroup_id_x 1
  .amdhsa_float_denorm_mode_32 3
.end_amdhsa_kernel
```
